```python
import torch

def _softmax(x, axis=-1):
    return torch.softmax(x, dim=axis)
def _gelu(x):
    return torch.nn.functional.gelu(x, approximate="tanh")
def _silu(x):
    return torch.nn.functional.silu(x)
def _sigmoid(x):
    return torch.sigmoid(x)
def _layernorm(x, axis=-1, eps=1e-5):
    m = x.mean(dim=axis, keepdim=True)
    v = x.var(dim=axis, keepdim=True, unbiased=False)
    return (x - m) / torch.sqrt(v + eps)
def _scatter_add(tgt, idx, src, axis=0):
    return tgt.clone().index_add_(axis, idx, src)
def _segment_sum(src, seg, n):
    out = torch.zeros((n,) + src.shape[1:], dtype=src.dtype)
    return out.index_add_(0, seg, src)
def _pad(x, pw):
    flat = tuple(v for pair in reversed(pw) for v in pair)
    return torch.nn.functional.pad(x, flat)

kernel_name = 'recurrent_scan__sliding_block_cached__glu_gated_geglu__decode'

def setup_inputs():

    _w = (lambda a: (lambda t: t.to(torch.bfloat16) if t.is_floating_point() else t)(torch.as_tensor(a)))
    def _A_setup():
        B, Sq, D = 2, 1, 512
        Hq, Hkv, Sk, Dh = 32, 32, 4096, 128
        assert Hq % Hkv == 0, (Hq, Hkv)
        return {
            "x": _w((lambda *s: torch.randn(*s, dtype=torch.bfloat16) * 0.2)(B, Sq, D)),
            "k_cache": _w((lambda *s: torch.randn(*s, dtype=torch.bfloat16) * 1.6)(B, Hkv, Sk, Dh)),
            "v_cache": _w((lambda *s: torch.randn(*s, dtype=torch.bfloat16) * 1.6)(B, Hkv, Sk, Dh)),
            "wq": _w((lambda *s: torch.randn(*s, dtype=torch.bfloat16) * 1.6)(D, Hq * Dh) * (D ** -0.5)),
            "wo": _w((lambda *s: torch.randn(*s, dtype=torch.bfloat16) * 1.6)(Hq * Dh, D) * ((Hq * Dh) ** -0.5)),
        }
    _A_in = _A_setup()

    def _B_setup():
        B, S, Dm, Df = 2, 1, 512, 1376
        return {
            "x": _w((lambda *s: torch.randn(*s, dtype=torch.bfloat16) * 0.2)(B, S, Dm)),
            "w_gate": _w((lambda *s: torch.randn(*s, dtype=torch.bfloat16) * 0.8)(Dm, Df) * (Dm ** -0.5)),
            "w_up": _w((lambda *s: torch.randn(*s, dtype=torch.bfloat16) * 0.8)(Dm, Df) * (Dm ** -0.5)),
            "w_down": _w((lambda *s: torch.randn(*s, dtype=torch.bfloat16) * 0.8)(Df, Dm) * (Df ** -0.5)),
        }
    _B_in = _B_setup()

    return {
        "A_x": _A_in["x"],
        "A_k_cache": _A_in["k_cache"],
        "A_v_cache": _A_in["v_cache"],
        "A_wq": _A_in["wq"],
        "A_wo": _A_in["wo"],
        "B_x": _B_in["x"],
        "B_w_gate": _B_in["w_gate"],
        "B_w_up": _B_in["w_up"],
        "B_w_down": _B_in["w_down"],
    }

def reference(A_x, A_k_cache, A_v_cache, A_wq, A_wo, B_x, B_w_gate, B_w_up, B_w_down):
    def _A_ref(x, k_cache, v_cache, wq, wo):
        B, Sq, D = x.shape
        Hq, Dh = 32, 128
        Hkv, Sk = k_cache.shape[1], k_cache.shape[2]
        W = min(4096, max(256, Sk // 4))
        rep = Hq // Hkv
        q = (lambda x, *d: x.permute(*d))((x @ wq).reshape(B, Sq, Hq, Dh), 0, 2, 1, 3)
        k = (lambda x, n, axis: torch.repeat_interleave(x, n, dim=axis))(k_cache[:, :, Sk - W:, :], rep, axis=1)
        v = (lambda x, n, axis: torch.repeat_interleave(x, n, dim=axis))(v_cache[:, :, Sk - W:, :], rep, axis=1)
        scores = torch.einsum("bhqd,bhkd->bhqk", q, k) * (Dh ** -0.5)
        p = _softmax(scores, axis=-1)
        o = torch.einsum("bhqk,bhkd->bhqd", p, v)
        return (lambda x, *d: x.permute(*d))(o, 0, 2, 1, 3).reshape(B, Sq, Hq * Dh) @ wo

    def _B_ref(x, w_gate, w_up, w_down):
        g = torch.einsum("bsd,df->bsf", x, w_gate)
        u = torch.einsum("bsd,df->bsf", x, w_up)
        h = _gelu(g) * u
        return torch.einsum("bsf,fd->bsd", h, w_down)

    x = A_x
    xn = _layernorm(x, axis=-1)
    s = _A_ref(xn, A_k_cache, A_v_cache, A_wq, A_wo)
    g = _silu(_B_ref(xn, B_w_gate, B_w_up, B_w_down))
    return x + s * g
```

```asm
; @launch grid=(256,1,1) block=(384,1,1) lds=4096
.amdgcn_target "amdgcn-amd-amdhsa--gfx950"
.text
.globl recurrent_scan__sliding_block_cached__glu_gated_geglu__decode_kernel
.p2align 8
.type recurrent_scan__sliding_block_cached__glu_gated_geglu__decode_kernel,@function
recurrent_scan__sliding_block_cached__glu_gated_geglu__decode_kernel:
    s_cmpk_ge_u32 s2, 0x100
    s_cbranch_scc1 L_end
    s_load_dwordx16 s[16:31], s[0:1], 0
    s_load_dwordx8 s[32:39], s[0:1], 64
    s_getpc_b64 s[48:49]
L_pc:
    v_readfirstlane_b32 s3, v0
    s_cmpk_ge_u32 s2, 32
    s_cbranch_scc1 L_nopf
    v_mul_u32_u24 v2, 36, v0
    global_load_dword v165, v2, s[48:49]
L_nopf:
    s_and_b32 s4, s2, 7
    s_lshr_b32 s5, s2, 3
    s_and_b32 s6, s5, 3
    s_lshl2_add_u32 s7, s4, s6
    s_lshr_b32 s8, s5, 2
    s_lshr_b32 s9, s8, 2
    s_and_b32 s10, s8, 3
    s_lshr_b32 s3, s3, 6
    v_and_b32 v0, 63, v0
    v_lshrrev_b32 v7, 4, v0
    s_sub_u32 s13, s3, 2
    s_cbranch_scc1 L_qf
    s_lshl_b32 s14, s9, 5
    s_add_u32 s14, s14, s7
    s_lshl2_add_u32 s14, s14, 3
    s_lshl2_add_u32 s14, s14, s10
    s_lshl2_add_u32 s14, s14, s13
    s_lshl_b32 s14, s14, 14
    v_and_b32 v9, 3, v0
    v_lshl_add_u32 v9, v7, 2, v9
    v_lshlrev_b32 v164, 4, v9
    v_bfe_u32 v10, v0, 2, 2
    v_lshl_add_u32 v9, v10, 8, v164
    s_xor_b32 s12, s10, s13
    s_lshl_b32 s12, s12, 12
    s_movk_i32 s54, 0x4000
    s_lshl_b32 s55, 1, 17
    s_waitcnt lgkmcnt(0)
    s_add_u32 s52, s18, s14
    s_addc_u32 s53, s19, 0
    buffer_load_dwordx4 v[32:35], v9, s[52:55], s12 offen offset:0 nt
    buffer_load_dwordx4 v[36:39], v9, s[52:55], s12 offen offset:1024 nt
    s_branch L_kv
L_qf:
    s_lshl_b32 s13, s7, 3
    s_load_dwordx2 s[50:51], s[48:49], s13 offset:13828
L_256:
    v_mov_b32 v1, 0
    v_bfe_u32 v25, v0, 3, 1
    v_lshlrev_b32 v25, 10, v25
    v_and_b32 v24, 7, v0
    v_lshl_add_u32 v24, v7, 3, v24
    v_lshl_add_u32 v24, v24, 5, v25
    v_lshl_add_u32 v25, v7, 5, v25
    s_lshl_b32 s13, s8, 7
    v_add_u32 v25, s13, v25
    s_cmp_eq_u32 s3, 1
    s_cbranch_scc1 L_f
    v_and_b32 v26, 15, v0
    v_lshlrev_b32 v26, 4, v26
    v_lshl_add_u32 v27, v7, 17, v26
    s_lshl_b32 s14, s8, 19
    s_lshl_b32 s15, s7, 8
    s_add_u32 s14, s14, s15
    s_lshl_b32 s54, 1, 22
    s_lshl_b32 s55, 1, 17
    s_mov_b32 s45, 0
    s_sub_u32 s54, s54, s14
    s_waitcnt lgkmcnt(0)
    global_load_dwordx4 v[8:11], v24, s[16:17]
    global_load_dwordx4 v[12:15], v24, s[16:17] offset:16
    global_load_dwordx4 v[16:19], v25, s[16:17]
    global_load_dwordx4 v[20:23], v25, s[16:17] offset:16
    s_add_u32 s52, s22, s14
    s_addc_u32 s53, s23, 0
    buffer_load_dwordx4 v[64:67], v27, s[52:55], s45 offen
    s_addk_i32 s45, 0x2000
    buffer_load_dwordx4 v[68:71], v27, s[52:55], s45 offen
    s_addk_i32 s45, 0x2000
    buffer_load_dwordx4 v[72:75], v27, s[52:55], s45 offen
    s_addk_i32 s45, 0x2000
    buffer_load_dwordx4 v[76:79], v27, s[52:55], s45 offen
    s_addk_i32 s45, 0x2000
    buffer_load_dwordx4 v[80:83], v27, s[52:55], s45 offen
    s_addk_i32 s45, 0x2000
    buffer_load_dwordx4 v[84:87], v27, s[52:55], s45 offen
    s_addk_i32 s45, 0x2000
    buffer_load_dwordx4 v[88:91], v27, s[52:55], s45 offen
    s_addk_i32 s45, 0x2000
    buffer_load_dwordx4 v[92:95], v27, s[52:55], s45 offen
    s_addk_i32 s45, 0x2000
    buffer_load_dwordx4 v[96:99], v27, s[52:55], s45 offen
    s_addk_i32 s45, 0x2000
    buffer_load_dwordx4 v[100:103], v27, s[52:55], s45 offen
    s_addk_i32 s45, 0x2000
    buffer_load_dwordx4 v[104:107], v27, s[52:55], s45 offen
    s_addk_i32 s45, 0x2000
    buffer_load_dwordx4 v[108:111], v27, s[52:55], s45 offen
    s_addk_i32 s45, 0x2000
    buffer_load_dwordx4 v[112:115], v27, s[52:55], s45 offen
    s_addk_i32 s45, 0x2000
    buffer_load_dwordx4 v[116:119], v27, s[52:55], s45 offen
    s_addk_i32 s45, 0x2000
    buffer_load_dwordx4 v[120:123], v27, s[52:55], s45 offen
    s_addk_i32 s45, 0x2000
    buffer_load_dwordx4 v[124:127], v27, s[52:55], s45 offen
    s_barrier
    s_load_dword s44, s[38:39], 263040
    s_lshl_b32 s13, s7, 13
    s_lshl_b32 s14, s8, 10
    s_add_u32 s14, s14, s13
    v_lshl_add_u32 v132, v0, 4, s14
    v_mov_b32 v128, 0
    v_mov_b32 v129, 0
    v_mov_b32 v130, 0
    v_mov_b32 v131, 0
    global_store_dwordx4 v132, v[128:131], s[38:39]
    v_and_b32 v6, 3, v0
    v_lshlrev_b32 v6, 4, v6
    v_mov_b32 v2, 0xffff
    v_mov_b32 v3, 0
    v_lshlrev_b64 v[2:3], v6, v[2:3]
    s_mov_b32 s62, 0xf0f0f0f0
    s_mov_b32 s63, s62
    v_cndmask_b32 v4, 0, v2, s[62:63]
    v_cndmask_b32 v5, 0, v3, s[62:63]
    v_cndmask_b32 v2, v2, 0, s[62:63]
    v_cndmask_b32 v3, v3, 0, s[62:63]
    v_mov_b32 v6, 0xff
    s_waitcnt vmcnt(17)
    s_branch L_ln
L_f:
    v_mul_u32_u24 v27, 44032, v7
    v_and_b32 v28, 3, v0
    v_lshl_add_u32 v27, v28, 4, v27
    s_mul_i32 s14, s8, 176128
    v_add_u32 v27, s14, v27
    v_and_b32 v148, 4, v0
    v_lshlrev_b32 v148, 1, v148
    s_mov_b32 s62, 0xff00ff00
    s_mov_b32 s63, s62
    s_movk_i32 s56, 5504
    s_mov_b32 s57, 0
    s_waitcnt lgkmcnt(0)
    global_load_dwordx4 v[8:11], v24, s[16:17]
    global_load_dwordx4 v[12:15], v24, s[16:17] offset:16
    global_load_dwordx4 v[16:19], v25, s[16:17]
    global_load_dwordx4 v[20:23], v25, s[16:17] offset:16
    v_lshrrev_b32 v148, v148, s50
    v_mov_b32 v28, s28
    v_mov_b32 v29, s29
    v_mov_b32 v30, s30
    v_mov_b32 v31, s31
    v_bfe_u32 v149, v148, 16, 8
    v_and_b32 v148, 0xff, v148
    v_cndmask_b32 v30, v28, v30, s[62:63]
    v_cndmask_b32 v31, v29, v31, s[62:63]
    v_lshl_add_u32 v26, v148, 6, v27
    v_lshl_add_u32 v27, v149, 6, v27
    v_add_co_u32 v28, vcc, v30, v26
    s_bfe_u32 s12, s51, 0x80008
    s_cmp_eq_u32 s12, 2
    v_addc_co_u32 v29, vcc, 0, v31, vcc
    v_add_co_u32 v30, vcc, v30, v27
    s_cselect_b64 s[52:53], -1, 1
    s_and_b32 s11, s51, 0xff
    v_addc_co_u32 v31, vcc, 0, v31, vcc
    global_load_dwordx4 v[64:67], v[28:29], off
    s_mov_b64 exec, s[52:53]
    global_load_dwordx4 v[96:99], v[30:31], off
    s_mov_b64 exec, -1
    v_lshl_add_u64 v[28:29], v[28:29], 0, s[56:57]
    v_lshl_add_u64 v[30:31], v[30:31], 0, s[56:57]
    global_load_dwordx4 v[68:71], v[28:29], off
    s_mov_b64 exec, s[52:53]
    global_load_dwordx4 v[100:103], v[30:31], off
    s_mov_b64 exec, -1
    v_lshl_add_u64 v[28:29], v[28:29], 0, s[56:57]
    v_lshl_add_u64 v[30:31], v[30:31], 0, s[56:57]
    global_load_dwordx4 v[72:75], v[28:29], off
    s_mov_b64 exec, s[52:53]
    global_load_dwordx4 v[104:107], v[30:31], off
    s_mov_b64 exec, -1
    v_lshl_add_u64 v[28:29], v[28:29], 0, s[56:57]
    v_lshl_add_u64 v[30:31], v[30:31], 0, s[56:57]
    global_load_dwordx4 v[76:79], v[28:29], off
    s_mov_b64 exec, s[52:53]
    global_load_dwordx4 v[108:111], v[30:31], off
    s_mov_b64 exec, -1
    v_lshl_add_u64 v[28:29], v[28:29], 0, s[56:57]
    v_lshl_add_u64 v[30:31], v[30:31], 0, s[56:57]
    global_load_dwordx4 v[80:83], v[28:29], off
    s_mov_b64 exec, s[52:53]
    global_load_dwordx4 v[112:115], v[30:31], off
    s_mov_b64 exec, -1
    v_lshl_add_u64 v[28:29], v[28:29], 0, s[56:57]
    v_lshl_add_u64 v[30:31], v[30:31], 0, s[56:57]
    global_load_dwordx4 v[84:87], v[28:29], off
    s_mov_b64 exec, s[52:53]
    global_load_dwordx4 v[116:119], v[30:31], off
    s_mov_b64 exec, -1
    v_lshl_add_u64 v[28:29], v[28:29], 0, s[56:57]
    v_lshl_add_u64 v[30:31], v[30:31], 0, s[56:57]
    global_load_dwordx4 v[88:91], v[28:29], off
    s_mov_b64 exec, s[52:53]
    global_load_dwordx4 v[120:123], v[30:31], off
    s_mov_b64 exec, -1
    v_lshl_add_u64 v[28:29], v[28:29], 0, s[56:57]
    v_lshl_add_u64 v[30:31], v[30:31], 0, s[56:57]
    global_load_dwordx4 v[92:95], v[28:29], off
    s_mov_b64 exec, s[52:53]
    global_load_dwordx4 v[124:127], v[30:31], off
    s_mov_b64 exec, -1
    s_barrier
    s_load_dword s44, s[38:39], 263040
    s_bfe_u32 s54, s51, 0x80010
    v_mov_b32 v132, 0
    v_and_b32 v6, 3, v0
    v_lshlrev_b32 v6, 4, v6
    v_mov_b32 v2, 0xffff
    v_mov_b32 v3, 0
    v_lshlrev_b64 v[2:3], v6, v[2:3]
    s_mov_b32 s62, 0xf0f0f0f0
    s_mov_b32 s63, s62
    v_cndmask_b32 v4, 0, v2, s[62:63]
    v_cndmask_b32 v5, 0, v3, s[62:63]
    v_cndmask_b32 v2, v2, 0, s[62:63]
    v_cndmask_b32 v3, v3, 0, s[62:63]
    v_mov_b32 v6, 0xff
    s_waitcnt vmcnt(16)
L_ln:
    v_lshlrev_b32 v24, 16, v8
    v_and_b32 v25, 0xffff0000, v8
    v_lshlrev_b32 v26, 16, v9
    v_and_b32 v27, 0xffff0000, v9
    v_lshlrev_b32 v28, 16, v10
    v_and_b32 v29, 0xffff0000, v10
    v_lshlrev_b32 v30, 16, v11
    v_and_b32 v31, 0xffff0000, v11
    v_lshlrev_b32 v32, 16, v12
    v_and_b32 v33, 0xffff0000, v12
    v_lshlrev_b32 v34, 16, v13
    v_and_b32 v35, 0xffff0000, v13
    v_lshlrev_b32 v36, 16, v14
    v_and_b32 v37, 0xffff0000, v14
    v_lshlrev_b32 v38, 16, v15
    v_and_b32 v39, 0xffff0000, v15
    v_pk_add_f32 v[8:9], v[24:25], v[26:27]
    v_pk_add_f32 v[8:9], v[8:9], v[28:29]
    v_pk_add_f32 v[8:9], v[8:9], v[30:31]
    v_pk_add_f32 v[8:9], v[8:9], v[32:33]
    v_pk_add_f32 v[8:9], v[8:9], v[34:35]
    v_pk_add_f32 v[8:9], v[8:9], v[36:37]
    v_pk_add_f32 v[8:9], v[8:9], v[38:39]
    v_add_f32 v8, v8, v9
    s_nop 1
    v_add_f32_dpp v8, v8, v8 quad_perm:[1,0,3,2] row_mask:0xf bank_mask:0xf
    s_nop 1
    v_add_f32_dpp v8, v8, v8 quad_perm:[2,3,0,1] row_mask:0xf bank_mask:0xf
    s_nop 1
    v_add_f32_dpp v8, v8, v8 row_half_mirror row_mask:0xf bank_mask:0xf
    v_mov_b32 v9, v8
    s_nop 1
    v_permlane16_swap_b32 v8, v9
    v_add_f32 v8, v8, v9
    v_mov_b32 v9, v8
    s_nop 1
    v_permlane32_swap_b32 v8, v9
    v_add_f32 v8, v8, v9
    v_mul_f32 v8, 0xbb000000, v8
    v_pk_add_f32 v[24:25], v[24:25], v[8:9] op_sel_hi:[1,0]
    v_pk_add_f32 v[26:27], v[26:27], v[8:9] op_sel_hi:[1,0]
    v_pk_add_f32 v[28:29], v[28:29], v[8:9] op_sel_hi:[1,0]
    v_pk_add_f32 v[30:31], v[30:31], v[8:9] op_sel_hi:[1,0]
    v_pk_add_f32 v[32:33], v[32:33], v[8:9] op_sel_hi:[1,0]
    v_pk_add_f32 v[34:35], v[34:35], v[8:9] op_sel_hi:[1,0]
    v_pk_add_f32 v[36:37], v[36:37], v[8:9] op_sel_hi:[1,0]
    v_pk_add_f32 v[38:39], v[38:39], v[8:9] op_sel_hi:[1,0]
    v_pk_mul_f32 v[10:11], v[24:25], v[24:25]
    v_pk_fma_f32 v[10:11], v[26:27], v[26:27], v[10:11]
    v_pk_fma_f32 v[10:11], v[28:29], v[28:29], v[10:11]
    v_pk_fma_f32 v[10:11], v[30:31], v[30:31], v[10:11]
    v_pk_fma_f32 v[10:11], v[32:33], v[32:33], v[10:11]
    v_pk_fma_f32 v[10:11], v[34:35], v[34:35], v[10:11]
    v_pk_fma_f32 v[10:11], v[36:37], v[36:37], v[10:11]
    v_pk_fma_f32 v[10:11], v[38:39], v[38:39], v[10:11]
    v_add_f32 v10, v10, v11
    s_nop 1
    v_add_f32_dpp v10, v10, v10 quad_perm:[1,0,3,2] row_mask:0xf bank_mask:0xf
    s_nop 1
    v_add_f32_dpp v10, v10, v10 quad_perm:[2,3,0,1] row_mask:0xf bank_mask:0xf
    s_nop 1
    v_add_f32_dpp v10, v10, v10 row_half_mirror row_mask:0xf bank_mask:0xf
    v_mov_b32 v9, v10
    s_nop 1
    v_permlane16_swap_b32 v10, v9
    v_add_f32 v10, v10, v9
    v_mov_b32 v9, v10
    s_nop 1
    v_permlane32_swap_b32 v10, v9
    v_add_f32 v10, v10, v9
    v_mul_f32 v10, 0x3b000000, v10
    v_cvt_pk_bf16_f32 v10, v8, v10
    v_lshlrev_b32 v8, 16, v10
    v_and_b32 v10, 0xffff0000, v10
    v_add_f32 v10, 0x3727c5ac, v10
    v_cvt_pk_bf16_f32 v10, v10, v10
    v_and_b32 v10, 0xffff0000, v10
    v_sqrt_f32 v10, v10
    s_nop 0
    v_cvt_pk_bf16_f32 v10, v10, v10
    v_and_b32 v10, 0xffff0000, v10
    v_rcp_f32 v10, v10
    v_lshlrev_b32 v24, 16, v16
    v_and_b32 v25, 0xffff0000, v16
    v_lshlrev_b32 v26, 16, v17
    v_and_b32 v27, 0xffff0000, v17
    v_lshlrev_b32 v28, 16, v18
    v_and_b32 v29, 0xffff0000, v18
    v_lshlrev_b32 v30, 16, v19
    v_and_b32 v31, 0xffff0000, v19
    v_lshlrev_b32 v32, 16, v20
    v_and_b32 v33, 0xffff0000, v20
    v_lshlrev_b32 v34, 16, v21
    v_and_b32 v35, 0xffff0000, v21
    v_lshlrev_b32 v36, 16, v22
    v_and_b32 v37, 0xffff0000, v22
    v_lshlrev_b32 v38, 16, v23
    v_and_b32 v39, 0xffff0000, v23
    v_pk_add_f32 v[24:25], v[24:25], v[8:9] op_sel_hi:[1,0]
    v_pk_add_f32 v[26:27], v[26:27], v[8:9] op_sel_hi:[1,0]
    v_pk_add_f32 v[28:29], v[28:29], v[8:9] op_sel_hi:[1,0]
    v_pk_add_f32 v[30:31], v[30:31], v[8:9] op_sel_hi:[1,0]
    v_pk_add_f32 v[32:33], v[32:33], v[8:9] op_sel_hi:[1,0]
    v_pk_add_f32 v[34:35], v[34:35], v[8:9] op_sel_hi:[1,0]
    v_pk_add_f32 v[36:37], v[36:37], v[8:9] op_sel_hi:[1,0]
    v_pk_add_f32 v[38:39], v[38:39], v[8:9] op_sel_hi:[1,0]
    v_cvt_pk_bf16_f32 v25, v24, v25
    v_lshlrev_b32 v24, 16, v25
    v_and_b32 v25, 0xffff0000, v25
    v_cvt_pk_bf16_f32 v27, v26, v27
    v_lshlrev_b32 v26, 16, v27
    v_and_b32 v27, 0xffff0000, v27
    v_cvt_pk_bf16_f32 v29, v28, v29
    v_lshlrev_b32 v28, 16, v29
    v_and_b32 v29, 0xffff0000, v29
    v_cvt_pk_bf16_f32 v31, v30, v31
    v_lshlrev_b32 v30, 16, v31
    v_and_b32 v31, 0xffff0000, v31
    v_cvt_pk_bf16_f32 v33, v32, v33
    v_lshlrev_b32 v32, 16, v33
    v_and_b32 v33, 0xffff0000, v33
    v_cvt_pk_bf16_f32 v35, v34, v35
    v_lshlrev_b32 v34, 16, v35
    v_and_b32 v35, 0xffff0000, v35
    v_cvt_pk_bf16_f32 v37, v36, v37
    v_lshlrev_b32 v36, 16, v37
    v_and_b32 v37, 0xffff0000, v37
    v_cvt_pk_bf16_f32 v39, v38, v39
    v_lshlrev_b32 v38, 16, v39
    v_and_b32 v39, 0xffff0000, v39
    v_pk_mul_f32 v[24:25], v[24:25], v[10:11] op_sel_hi:[1,0]
    v_pk_mul_f32 v[26:27], v[26:27], v[10:11] op_sel_hi:[1,0]
    v_pk_mul_f32 v[28:29], v[28:29], v[10:11] op_sel_hi:[1,0]
    v_pk_mul_f32 v[30:31], v[30:31], v[10:11] op_sel_hi:[1,0]
    v_pk_mul_f32 v[32:33], v[32:33], v[10:11] op_sel_hi:[1,0]
    v_pk_mul_f32 v[34:35], v[34:35], v[10:11] op_sel_hi:[1,0]
    v_pk_mul_f32 v[36:37], v[36:37], v[10:11] op_sel_hi:[1,0]
    v_pk_mul_f32 v[38:39], v[38:39], v[10:11] op_sel_hi:[1,0]
    v_cvt_pk_bf16_f32 v40, v24, v24
    v_cvt_pk_bf16_f32 v41, v25, v25
    v_cvt_pk_bf16_f32 v42, v26, v26
    v_cvt_pk_bf16_f32 v43, v27, v27
    v_cvt_pk_bf16_f32 v44, v28, v28
    v_cvt_pk_bf16_f32 v45, v29, v29
    v_cvt_pk_bf16_f32 v46, v30, v30
    v_cvt_pk_bf16_f32 v47, v31, v31
    v_cvt_pk_bf16_f32 v48, v32, v32
    v_cvt_pk_bf16_f32 v49, v33, v33
    v_cvt_pk_bf16_f32 v50, v34, v34
    v_cvt_pk_bf16_f32 v51, v35, v35
    v_cvt_pk_bf16_f32 v52, v36, v36
    v_cvt_pk_bf16_f32 v53, v37, v37
    v_cvt_pk_bf16_f32 v54, v38, v38
    v_cvt_pk_bf16_f32 v55, v39, v39
    s_waitcnt lgkmcnt(0)
    s_add_u32 s44, s44, 0x01010101
    s_or_b32 s44, s44, 0x80808080
    s_getreg_b32 s47, hwreg(HW_REG_XCC_ID, 0, 4)
    s_and_b32 s40, s44, 0xff
    s_bfe_u32 s41, s44, 0x80008
    s_bfe_u32 s42, s44, 0x80010
    s_lshr_b32 s46, s44, 24
    s_add_u32 s47, s47, 16
    s_xor_b32 s47, s47, s46
    s_cmp_eq_u32 s3, 1
    s_cbranch_scc1 L_f3
    s_lshl_b32 s15, s9, 9
    s_add_u32 s15, s15, s13
    s_add_u32 s15, s15, 4096
    v_and_b32 v26, 31, v0
    v_lshlrev_b32 v26, 4, v26
    v_lshrrev_b32 v27, 5, v0
    v_lshl_add_u32 v26, v27, 10, v26
    v_add_u32 v26, s15, v26
    v_and_b32 v56, v40, v2
    v_and_b32 v57, v40, v3
    v_and_b32 v58, v40, v4
    v_and_b32 v59, v40, v5
    v_and_b32 v60, v41, v2
    v_and_b32 v61, v41, v3
    v_and_b32 v62, v41, v4
    v_and_b32 v63, v41, v5
    s_waitcnt vmcnt(16)
    v_mfma_f32_16x16x32_bf16 v[128:131], v[56:59], v[64:67], 0
    v_and_b32 v56, v42, v2
    v_and_b32 v57, v42, v3
    v_and_b32 v58, v42, v4
    v_and_b32 v59, v42, v5
    s_waitcnt vmcnt(15)
    v_mfma_f32_16x16x32_bf16 v[128:131], v[60:63], v[68:71], v[128:131]
    v_and_b32 v60, v43, v2
    v_and_b32 v61, v43, v3
    v_and_b32 v62, v43, v4
    v_and_b32 v63, v43, v5
    s_waitcnt vmcnt(14)
    v_mfma_f32_16x16x32_bf16 v[128:131], v[56:59], v[72:75], v[128:131]
    v_and_b32 v56, v44, v2
    v_and_b32 v57, v44, v3
    v_and_b32 v58, v44, v4
    v_and_b32 v59, v44, v5
    s_waitcnt vmcnt(13)
    v_mfma_f32_16x16x32_bf16 v[128:131], v[60:63], v[76:79], v[128:131]
    v_and_b32 v60, v45, v2
    v_and_b32 v61, v45, v3
    v_and_b32 v62, v45, v4
    v_and_b32 v63, v45, v5
    s_waitcnt vmcnt(12)
    v_mfma_f32_16x16x32_bf16 v[128:131], v[56:59], v[80:83], v[128:131]
    v_and_b32 v56, v46, v2
    v_and_b32 v57, v46, v3
    v_and_b32 v58, v46, v4
    v_and_b32 v59, v46, v5
    s_waitcnt vmcnt(11)
    v_mfma_f32_16x16x32_bf16 v[128:131], v[60:63], v[84:87], v[128:131]
    v_and_b32 v60, v47, v2
    v_and_b32 v61, v47, v3
    v_and_b32 v62, v47, v4
    v_and_b32 v63, v47, v5
    s_waitcnt vmcnt(10)
    v_mfma_f32_16x16x32_bf16 v[128:131], v[56:59], v[88:91], v[128:131]
    v_and_b32 v56, v48, v2
    v_and_b32 v57, v48, v3
    v_and_b32 v58, v48, v4
    v_and_b32 v59, v48, v5
    s_waitcnt vmcnt(9)
    v_mfma_f32_16x16x32_bf16 v[128:131], v[60:63], v[92:95], v[128:131]
    v_and_b32 v60, v49, v2
    v_and_b32 v61, v49, v3
    v_and_b32 v62, v49, v4
    v_and_b32 v63, v49, v5
    s_waitcnt vmcnt(8)
    v_mfma_f32_16x16x32_bf16 v[128:131], v[56:59], v[96:99], v[128:131]
    v_and_b32 v56, v50, v2
    v_and_b32 v57, v50, v3
    v_and_b32 v58, v50, v4
    v_and_b32 v59, v50, v5
    s_waitcnt vmcnt(7)
    v_mfma_f32_16x16x32_bf16 v[128:131], v[60:63], v[100:103], v[128:131]
    v_and_b32 v60, v51, v2
    v_and_b32 v61, v51, v3
    v_and_b32 v62, v51, v4
    v_and_b32 v63, v51, v5
    s_waitcnt vmcnt(6)
    v_mfma_f32_16x16x32_bf16 v[128:131], v[56:59], v[104:107], v[128:131]
    v_and_b32 v56, v52, v2
    v_and_b32 v57, v52, v3
    v_and_b32 v58, v52, v4
    v_and_b32 v59, v52, v5
    s_waitcnt vmcnt(5)
    v_mfma_f32_16x16x32_bf16 v[128:131], v[60:63], v[108:111], v[128:131]
    v_and_b32 v60, v53, v2
    v_and_b32 v61, v53, v3
    v_and_b32 v62, v53, v4
    v_and_b32 v63, v53, v5
    s_waitcnt vmcnt(4)
    v_mfma_f32_16x16x32_bf16 v[128:131], v[56:59], v[112:115], v[128:131]
    v_and_b32 v56, v54, v2
    v_and_b32 v57, v54, v3
    v_and_b32 v58, v54, v4
    v_and_b32 v59, v54, v5
    s_waitcnt vmcnt(3)
    v_mfma_f32_16x16x32_bf16 v[128:131], v[60:63], v[116:119], v[128:131]
    v_and_b32 v60, v55, v2
    v_and_b32 v61, v55, v3
    v_and_b32 v62, v55, v4
    v_and_b32 v63, v55, v5
    s_waitcnt vmcnt(2)
    v_mfma_f32_16x16x32_bf16 v[128:131], v[56:59], v[120:123], v[128:131]
    s_waitcnt vmcnt(1)
    v_mfma_f32_16x16x32_bf16 v[128:131], v[60:63], v[124:127], v[128:131]
    s_nop 7
    v_bfi_b32 v128, v6, s40, v128
    v_bfi_b32 v129, v6, s41, v129
    v_bfi_b32 v130, v6, s42, v130
    v_bfi_b32 v131, v6, s47, v131
    global_store_dwordx4 v132, v[128:131], s[38:39]
    s_mov_b32 s60, 0
    s_mov_b32 s61, 0
    s_mov_b32 s43, s47
Lp_1:
    global_load_dwordx4 v[8:11], v26, s[38:39] offset:-4096 sc1
    global_load_dwordx4 v[12:15], v26, s[38:39] offset:-2048 sc1
    global_load_dwordx4 v[16:19], v26, s[38:39] offset:0 sc1
    global_load_dwordx4 v[20:23], v26, s[38:39] offset:2048 sc1
    s_add_u32 s60, s60, 1
    s_waitcnt vmcnt(0)
    v_xor_b32 v8, s40, v8
    v_xor_b32 v9, s41, v9
    v_xor_b32 v10, s42, v10
    v_xor_b32 v11, s43, v11
    v_xor_b32 v12, s40, v12
    v_xor_b32 v13, s41, v13
    v_xor_b32 v14, s42, v14
    v_xor_b32 v15, s43, v15
    v_xor_b32 v16, s40, v16
    v_xor_b32 v17, s41, v17
    v_xor_b32 v18, s42, v18
    v_xor_b32 v19, s43, v19
    v_xor_b32 v20, s40, v20
    v_xor_b32 v21, s41, v21
    v_xor_b32 v22, s42, v22
    v_xor_b32 v23, s43, v23
    v_or3_b32 v27, v8, v9, v10
    v_or3_b32 v27, v27, v11, v12
    v_or3_b32 v27, v27, v13, v14
    v_or3_b32 v27, v27, v15, v16
    v_or3_b32 v27, v27, v17, v18
    v_or3_b32 v27, v27, v19, v20
    v_or3_b32 v27, v27, v21, v22
    v_bitop3_b32 v27, v27, v23, v6 bitop3:0xa8
    v_cmp_ne_u32 vcc, 0, v27
    s_cbranch_vccz Lpx_2
    s_cmp_lt_u32 s60, 8
    s_cbranch_scc1 Lp_1
    s_cmp_lg_u32 s60, 8
    s_cbranch_scc1 Lpn_3
    v_bfi_b32 v131, v6, s46, v131
    v_add_u32 v132, 2097152, v132
    global_store_dwordx4 v132, v[128:131], s[38:39] sc1
Lpn_3:
    s_xor_b32 s61, s61, 2097152
    s_cselect_b32 s43, s46, s47
    v_xor_b32 v26, 2097152, v26
    s_cmp_lt_u32 s60, 65536
    s_cbranch_scc1 Lp_1
Lpx_2:
    v_pk_add_f32 v[8:9], v[8:9], v[12:13]
    v_pk_add_f32 v[10:11], v[10:11], v[14:15]
    v_pk_add_f32 v[16:17], v[16:17], v[20:21]
    v_pk_add_f32 v[18:19], v[18:19], v[22:23]
    v_pk_add_f32 v[8:9], v[8:9], v[16:17]
    v_pk_add_f32 v[10:11], v[10:11], v[18:19]
    v_and_b32 v12, 15, v0
    v_lshlrev_b32 v12, 4, v12
    v_permlane32_swap_b32 v8, v10
    v_permlane32_swap_b32 v9, v11
    v_pk_add_f32 v[8:9], v[8:9], v[10:11]
    v_bfe_u32 v10, v0, 4, 1
    v_cvt_pk_bf16_f32 v8, v8, v9
    v_lshl_add_u32 v9, v10, 3, v12
    v_lshrrev_b32 v10, 5, v0
    v_lshl_add_u32 v9, v10, 2, v9
    ds_write_b32 v9, v8 offset:64
    ds_write_b32 v1, v6 offset:0
    v_and_b32 v20, 7, v0
    v_bfe_u32 v21, v0, 3, 1
    v_lshlrev_b32 v22, 4, v20
    v_and_b32 v23, 15, v0
    v_lshrrev_b32 v30, 5, v0
    v_lshl_add_u32 v23, v30, 4, v23
    s_lshl_b32 s14, s5, 17
    s_lshl_b32 s15, s4, 7
    s_add_u32 s14, s14, s15
    s_add_u32 s14, s14, 4096
    s_add_u32 s24, s24, s14
    s_addc_u32 s25, s25, 0
    v_lshl_add_u32 v24, v21, 10, v22
    v_lshl_add_u32 v24, v7, 15, v24
    v_add_u32 v25, 0x2000, v24
    v_add_u32 v32, 0x4000, v24
    v_add_u32 v33, 0x6000, v24
    v_lshl_add_u32 v26, v7, 7, v22
    s_mul_i32 s14, s5, 8192
    s_add_u32 s14, s14, 4194304
    v_mul_u32_u24 v28, 2048, v21
    v_add3_u32 v26, v26, v28, s14
    s_add_u32 s14, s14, 4096
    v_lshl_add_u32 v27, v21, 9, s14
    v_and_b32 v28, 3, v0
    v_lshl_add_u32 v27, v28, 7, v27
    v_lshlrev_b32 v28, 3, v28
    s_mul_i32 s14, s7, 8192
    s_lshl_b32 s15, s8, 7
    s_add_u32 s14, s14, s15
    s_add_u32 s14, s14, 4198400
    v_lshl_add_u32 v31, v0, 4, s14
    s_sub_u32 s14, s7, s5
    s_mul_i32 s14, s14, 8192
    v_add_u32 v157, s14, v27
    s_xor_b32 s52, s47, 0x20
    s_xor_b32 s53, s46, 0x20
    s_lshl_b32 s14, s8, 10
    s_add_u32 s14, s14, s13
    v_lshl_add_u32 v29, v23, 4, s14
    v_or_b32 v34, v2, v4
    v_or_b32 v35, v3, v5
    v_or_b32 v34, v34, v35
    s_mov_b32 s62, 0xffff0000
    s_mov_b32 s63, s62
    s_mov_b32 s60, 0
L_qm:
    ds_read_b64 v[8:9], v28 offset:16
    s_add_u32 s60, s60, 1
    s_waitcnt lgkmcnt(0)
    v_cmp_eq_u32 vcc, 0, v9
    s_cbranch_vccz L_qm2
    s_sleep 1
    s_cmp_lt_u32 s60, 65536
    s_cbranch_scc1 L_qm
L_qm2:
    v_max_f32_dpp v12, v8, v8 quad_perm:[1,0,3,2] row_mask:0xf bank_mask:0xf
    s_nop 1
    v_max_f32_dpp v12, v12, v12 quad_perm:[2,3,0,1] row_mask:0xf bank_mask:0xf
    v_sub_f32 v8, v8, v12
    v_mul_f32 v8, 0x3fb8aa3b, v8
    v_exp_f32 v8, v8
    s_nop 0
    v_mul_f32 v13, v8, v9
    s_nop 1
    v_add_f32_dpp v13, v13, v13 quad_perm:[1,0,3,2] row_mask:0xf bank_mask:0xf
    s_nop 1
    v_add_f32_dpp v13, v13, v13 quad_perm:[2,3,0,1] row_mask:0xf bank_mask:0xf
    v_bfi_b32 v12, v6, s40, v12
    v_bfi_b32 v13, v6, s41, v13
    v_mov_b32 v14, s42
    v_mov_b32 v15, s46
    s_mov_b64 exec, 0xff
    global_store_dwordx4 v31, v[12:15], s[38:39] sc1
    s_mov_b64 exec, -1
    s_mov_b32 s60, 0
Lg_4:
    ds_read_b32 v30, v1 offset:48
    s_add_u32 s60, s60, 1
    s_waitcnt lgkmcnt(0)
    v_cmp_le_u32 vcc, 1, v30
    s_cbranch_vccnz Lgx_5
    s_sleep 2
    s_cmp_lt_u32 s60, 65536
    s_cbranch_scc1 Lg_4
Lgx_5:
    v_readfirstlane_b32 s58, v30
    s_mov_b32 s60, 0
Lg_6:
    ds_read_b32 v30, v1 offset:8
    s_add_u32 s60, s60, 1
    s_waitcnt lgkmcnt(0)
    v_cmp_le_u32 vcc, 4, v30
    s_cbranch_vccnz Lgx_7
    s_sleep 1
    s_cmp_lt_u32 s60, 65536
    s_cbranch_scc1 Lg_6
Lgx_7:
    v_lshlrev_b32 v36, 16, v0
    s_mov_b32 exec_lo, 0x3
    s_mov_b32 exec_hi, 0
    global_load_dword v36, v36, s[24:25] offset:-4096
    s_mov_b64 exec, -1
    s_lshl_b32 s45, s4, 12
    s_add_u32 s45, s45, 1474560
    s_mov_b32 s60, 0
Lg_8:
    s_add_u32 s60, s60, 1
    s_add_u32 s61, s5, s60
    s_and_b32 s61, s61, 3
    s_lshl_b32 s61, s61, 7
    s_add_u32 s61, s61, s45
    s_cmp_gt_u32 s60, 4
    s_cselect_b32 s43, 64, 0
    s_add_u32 s61, s61, s43
    s_load_dword s16, s[38:39], s61 offset:0
    s_load_dword s17, s[38:39], s61 offset:512
    s_load_dword s18, s[38:39], s61 offset:1024
    s_load_dword s19, s[38:39], s61 offset:1536
    s_load_dword s20, s[38:39], s61 offset:2048
    s_load_dword s21, s[38:39], s61 offset:2560
    s_load_dword s22, s[38:39], s61 offset:3072
    s_load_dword s23, s[38:39], s61 offset:3584
    s_mov_b32 s43, 0
    s_waitcnt lgkmcnt(0)
    ds_read_b32 v30, v1 offset:4
    s_cmp_eq_u32 s16, s44
    s_addc_u32 s43, s43, 0
    s_cmp_eq_u32 s17, s44
    s_addc_u32 s43, s43, 0
    s_cmp_eq_u32 s18, s44
    s_addc_u32 s43, s43, 0
    s_cmp_eq_u32 s19, s44
    s_addc_u32 s43, s43, 0
    s_cmp_eq_u32 s20, s44
    s_addc_u32 s43, s43, 0
    s_cmp_eq_u32 s21, s44
    s_addc_u32 s43, s43, 0
    s_cmp_eq_u32 s22, s44
    s_addc_u32 s43, s43, 0
    s_cmp_eq_u32 s23, s44
    s_addc_u32 s43, s43, 0
    s_cmp_ge_u32 s43, 8
    s_cbranch_scc1 Lgx_9
    s_waitcnt lgkmcnt(0)
    v_cmp_le_u32 vcc, 3, v30
    s_cbranch_vccnz Lgx_9
    s_cmp_lt_u32 s60, 8
    s_cbranch_scc1 Lg_8
Lgx_9b:
    s_mov_b32 s60, 0
Lg_10:
    ds_read_b32 v30, v1 offset:4
    s_add_u32 s60, s60, 1
    s_waitcnt lgkmcnt(0)
    v_cmp_le_u32 vcc, 3, v30
    s_cbranch_vccnz Lgx_11
    s_sleep 1
    s_cmp_lt_u32 s60, 65536
    s_cbranch_scc1 Lg_10
Lgx_11:
Lgx_9:
    s_waitcnt lgkmcnt(0)
L_dry:
    global_load_dwordx4 v[8:11], v27, s[38:39] sc1
    global_load_dwordx4 v[68:71], v24, s[24:25] offset:-4096
    global_load_dwordx4 v[72:75], v24, s[24:25] offset:-2048
    global_load_dwordx4 v[76:79], v24, s[24:25] offset:0
    global_load_dwordx4 v[80:83], v24, s[24:25] offset:2048
    ds_read_b32 v30, v1 offset:4
    s_waitcnt lgkmcnt(0)
    v_cmp_le_u32 vcc, 5, v30
L_wt3:
    global_load_dwordx4 v[84:87], v25, s[24:25] offset:-4096
    s_cbranch_vccnz L_wt4
    ds_read_b32 v30, v1 offset:4
    s_waitcnt lgkmcnt(0)
    v_cmp_le_u32 vcc, 5, v30
L_wt4:
    global_load_dwordx4 v[88:91], v25, s[24:25] offset:-2048
    s_cbranch_vccnz L_wt5
    ds_read_b32 v30, v1 offset:4
    s_waitcnt lgkmcnt(0)
    v_cmp_le_u32 vcc, 5, v30
L_wt5:
    global_load_dwordx4 v[92:95], v25, s[24:25] offset:0
    s_cbranch_vccnz L_wt6
    ds_read_b32 v30, v1 offset:4
    s_waitcnt lgkmcnt(0)
    v_cmp_le_u32 vcc, 5, v30
L_wt6:
    global_load_dwordx4 v[96:99], v25, s[24:25] offset:2048
    s_cbranch_vccnz L_wt7
    ds_read_b32 v30, v1 offset:4
    s_waitcnt lgkmcnt(0)
    v_cmp_le_u32 vcc, 5, v30
L_wt7:
    global_load_dwordx4 v[100:103], v32, s[24:25] offset:-4096
    s_cbranch_vccnz L_wt8
    ds_read_b32 v30, v1 offset:4
    s_waitcnt lgkmcnt(0)
    v_cmp_le_u32 vcc, 5, v30
L_wt8:
    global_load_dwordx4 v[104:107], v32, s[24:25] offset:-2048
    s_cbranch_vccnz L_wt9
    ds_read_b32 v30, v1 offset:4
    s_waitcnt lgkmcnt(0)
    v_cmp_le_u32 vcc, 5, v30
L_wt9:
    global_load_dwordx4 v[108:111], v32, s[24:25] offset:0
    s_cbranch_vccnz L_wt10
    ds_read_b32 v30, v1 offset:4
    s_waitcnt lgkmcnt(0)
    v_cmp_le_u32 vcc, 5, v30
L_wt10:
    global_load_dwordx4 v[112:115], v32, s[24:25] offset:2048
    s_cbranch_vccnz L_wt11
    ds_read_b32 v30, v1 offset:4
    s_waitcnt lgkmcnt(0)
    v_cmp_le_u32 vcc, 5, v30
L_wt11:
    global_load_dwordx4 v[116:119], v33, s[24:25] offset:-4096
    s_cbranch_vccnz L_wt12
    ds_read_b32 v30, v1 offset:4
    s_waitcnt lgkmcnt(0)
    v_cmp_le_u32 vcc, 5, v30
L_wt12:
    global_load_dwordx4 v[120:123], v33, s[24:25] offset:-2048
    s_cbranch_vccnz L_wt13
    ds_read_b32 v30, v1 offset:4
    s_waitcnt lgkmcnt(0)
    v_cmp_le_u32 vcc, 5, v30
L_wt13:
    global_load_dwordx4 v[124:127], v33, s[24:25] offset:0
    s_cbranch_vccnz L_wt14
    ds_read_b32 v30, v1 offset:4
    s_waitcnt lgkmcnt(0)
    v_cmp_le_u32 vcc, 5, v30
L_wt14:
    global_load_dwordx4 v[128:131], v33, s[24:25] offset:2048
    s_waitcnt vmcnt(16)
    v_xor_b32 v8, s40, v8
    v_xor_b32 v9, s41, v9
    v_xor_b32 v10, s42, v10
    v_xor_b32 v11, s46, v11
    v_or3_b32 v30, v8, v9, v10
    v_bitop3_b32 v30, v30, v11, v6 bitop3:0xa8
    v_cmp_ne_u32 vcc, 0, v30
    s_mov_b64 s[56:57], vcc
    s_cbranch_vccz L_ml1
    global_load_dwordx4 v[8:11], v27, s[38:39] sc1
    s_branch L_ml2
L_ml1:
    v_max_f32_dpp v10, v8, v8 quad_perm:[1,0,3,2] row_mask:0xf bank_mask:0xf
    s_nop 1
    v_max_f32_dpp v10, v10, v10 quad_perm:[2,3,0,1] row_mask:0xf bank_mask:0xf
    v_sub_f32 v8, v8, v10
    v_mul_f32 v8, 0x3fb8aa3b, v8
    v_exp_f32 v8, v8
    s_nop 0
    v_mul_f32 v9, v9, v8
    s_nop 1
    v_add_f32_dpp v9, v9, v9 quad_perm:[1,0,3,2] row_mask:0xf bank_mask:0xf
    s_nop 1
    v_add_f32_dpp v9, v9, v9 quad_perm:[2,3,0,1] row_mask:0xf bank_mask:0xf
    v_rcp_f32 v9, v9
    s_nop 0
    v_mul_f32 v8, v8, v9
    s_nop 1
    v_mov_b32_dpp v12, v8 quad_perm:[0,0,0,0] row_mask:0xf bank_mask:0xf
    v_mov_b32_dpp v13, v8 quad_perm:[1,1,1,1] row_mask:0xf bank_mask:0xf
    v_mov_b32_dpp v14, v8 quad_perm:[2,2,2,2] row_mask:0xf bank_mask:0xf
    v_mov_b32_dpp v15, v8 quad_perm:[3,3,3,3] row_mask:0xf bank_mask:0xf
L_ml2:
    s_mov_b32 vcc_lo, 0xff00ff00
    s_mov_b32 vcc_hi, vcc_lo
    s_waitcnt vmcnt(15)
    v_cndmask_b32_dpp v61, v68, v70, vcc row_ror:8 row_mask:0xf bank_mask:0xf
    v_cndmask_b32_dpp v65, v69, v71, vcc row_ror:8 row_mask:0xf bank_mask:0xf
    s_waitcnt vmcnt(14)
    v_cndmask_b32_dpp v63, v72, v74, vcc row_ror:8 row_mask:0xf bank_mask:0xf
    v_cndmask_b32_dpp v67, v73, v75, vcc row_ror:8 row_mask:0xf bank_mask:0xf
    s_not_b64 vcc, vcc
    v_cndmask_b32_dpp v60, v70, v68, vcc row_ror:8 row_mask:0xf bank_mask:0xf
    v_cndmask_b32_dpp v64, v71, v69, vcc row_ror:8 row_mask:0xf bank_mask:0xf
    v_cndmask_b32_dpp v62, v74, v72, vcc row_ror:8 row_mask:0xf bank_mask:0xf
    v_cndmask_b32_dpp v66, v75, v73, vcc row_ror:8 row_mask:0xf bank_mask:0xf
    s_waitcnt vmcnt(13)
    v_cndmask_b32_dpp v68, v78, v76, vcc row_ror:8 row_mask:0xf bank_mask:0xf
    v_cndmask_b32_dpp v72, v79, v77, vcc row_ror:8 row_mask:0xf bank_mask:0xf
    s_waitcnt vmcnt(12)
    v_cndmask_b32_dpp v70, v82, v80, vcc row_ror:8 row_mask:0xf bank_mask:0xf
    v_cndmask_b32_dpp v74, v83, v81, vcc row_ror:8 row_mask:0xf bank_mask:0xf
    s_not_b64 vcc, vcc
    v_cndmask_b32_dpp v69, v76, v78, vcc row_ror:8 row_mask:0xf bank_mask:0xf
    v_cndmask_b32_dpp v73, v77, v79, vcc row_ror:8 row_mask:0xf bank_mask:0xf
    v_cndmask_b32_dpp v71, v80, v82, vcc row_ror:8 row_mask:0xf bank_mask:0xf
    v_cndmask_b32_dpp v75, v81, v83, vcc row_ror:8 row_mask:0xf bank_mask:0xf
    s_waitcnt vmcnt(11)
    v_cndmask_b32_dpp v77, v84, v86, vcc row_ror:8 row_mask:0xf bank_mask:0xf
    v_cndmask_b32_dpp v81, v85, v87, vcc row_ror:8 row_mask:0xf bank_mask:0xf
    s_waitcnt vmcnt(10)
    v_cndmask_b32_dpp v79, v88, v90, vcc row_ror:8 row_mask:0xf bank_mask:0xf
    v_cndmask_b32_dpp v83, v89, v91, vcc row_ror:8 row_mask:0xf bank_mask:0xf
    s_not_b64 vcc, vcc
    v_cndmask_b32_dpp v76, v86, v84, vcc row_ror:8 row_mask:0xf bank_mask:0xf
    v_cndmask_b32_dpp v80, v87, v85, vcc row_ror:8 row_mask:0xf bank_mask:0xf
    v_cndmask_b32_dpp v78, v90, v88, vcc row_ror:8 row_mask:0xf bank_mask:0xf
    v_cndmask_b32_dpp v82, v91, v89, vcc row_ror:8 row_mask:0xf bank_mask:0xf
    global_load_dwordx4 v[160:163], v157, s[38:39] sc1
    global_load_dwordx4 v[40:43], v26, s[38:39] offset:0 sc1
    global_load_dwordx4 v[44:47], v26, s[38:39] offset:512 sc1
    global_load_dwordx4 v[48:51], v26, s[38:39] offset:1024 sc1
    global_load_dwordx4 v[52:55], v26, s[38:39] offset:1536 sc1
L_late:
    s_mov_b32 s61, 0
    s_mov_b32 vcc_lo, 0xff00ff00
    s_mov_b32 vcc_hi, vcc_lo
    s_waitcnt vmcnt(14)
    v_cndmask_b32_dpp v85, v92, v94, vcc row_ror:8 row_mask:0xf bank_mask:0xf
    v_cndmask_b32_dpp v89, v93, v95, vcc row_ror:8 row_mask:0xf bank_mask:0xf
    s_waitcnt vmcnt(13)
    v_cndmask_b32_dpp v87, v96, v98, vcc row_ror:8 row_mask:0xf bank_mask:0xf
    v_cndmask_b32_dpp v91, v97, v99, vcc row_ror:8 row_mask:0xf bank_mask:0xf
    s_not_b64 vcc, vcc
    v_cndmask_b32_dpp v84, v94, v92, vcc row_ror:8 row_mask:0xf bank_mask:0xf
    v_cndmask_b32_dpp v88, v95, v93, vcc row_ror:8 row_mask:0xf bank_mask:0xf
    v_cndmask_b32_dpp v86, v98, v96, vcc row_ror:8 row_mask:0xf bank_mask:0xf
    v_cndmask_b32_dpp v90, v99, v97, vcc row_ror:8 row_mask:0xf bank_mask:0xf
    s_waitcnt vmcnt(12)
    v_cndmask_b32_dpp v92, v102, v100, vcc row_ror:8 row_mask:0xf bank_mask:0xf
    v_cndmask_b32_dpp v96, v103, v101, vcc row_ror:8 row_mask:0xf bank_mask:0xf
    s_waitcnt vmcnt(11)
    v_cndmask_b32_dpp v94, v106, v104, vcc row_ror:8 row_mask:0xf bank_mask:0xf
    v_cndmask_b32_dpp v98, v107, v105, vcc row_ror:8 row_mask:0xf bank_mask:0xf
    s_not_b64 vcc, vcc
    v_cndmask_b32_dpp v93, v100, v102, vcc row_ror:8 row_mask:0xf bank_mask:0xf
    v_cndmask_b32_dpp v97, v101, v103, vcc row_ror:8 row_mask:0xf bank_mask:0xf
    v_cndmask_b32_dpp v95, v104, v106, vcc row_ror:8 row_mask:0xf bank_mask:0xf
    v_cndmask_b32_dpp v99, v105, v107, vcc row_ror:8 row_mask:0xf bank_mask:0xf
    s_waitcnt vmcnt(10)
    v_cndmask_b32_dpp v101, v108, v110, vcc row_ror:8 row_mask:0xf bank_mask:0xf
    v_cndmask_b32_dpp v105, v109, v111, vcc row_ror:8 row_mask:0xf bank_mask:0xf
    s_waitcnt vmcnt(9)
    v_cndmask_b32_dpp v103, v112, v114, vcc row_ror:8 row_mask:0xf bank_mask:0xf
    v_cndmask_b32_dpp v107, v113, v115, vcc row_ror:8 row_mask:0xf bank_mask:0xf
    s_not_b64 vcc, vcc
    v_cndmask_b32_dpp v100, v110, v108, vcc row_ror:8 row_mask:0xf bank_mask:0xf
    v_cndmask_b32_dpp v104, v111, v109, vcc row_ror:8 row_mask:0xf bank_mask:0xf
    v_cndmask_b32_dpp v102, v114, v112, vcc row_ror:8 row_mask:0xf bank_mask:0xf
    v_cndmask_b32_dpp v106, v115, v113, vcc row_ror:8 row_mask:0xf bank_mask:0xf
    s_waitcnt vmcnt(8)
    v_cndmask_b32_dpp v108, v118, v116, vcc row_ror:8 row_mask:0xf bank_mask:0xf
    v_cndmask_b32_dpp v112, v119, v117, vcc row_ror:8 row_mask:0xf bank_mask:0xf
    s_waitcnt vmcnt(7)
    v_cndmask_b32_dpp v110, v122, v120, vcc row_ror:8 row_mask:0xf bank_mask:0xf
    v_cndmask_b32_dpp v114, v123, v121, vcc row_ror:8 row_mask:0xf bank_mask:0xf
    s_not_b64 vcc, vcc
    v_cndmask_b32_dpp v109, v116, v118, vcc row_ror:8 row_mask:0xf bank_mask:0xf
    v_cndmask_b32_dpp v113, v117, v119, vcc row_ror:8 row_mask:0xf bank_mask:0xf
    v_cndmask_b32_dpp v111, v120, v122, vcc row_ror:8 row_mask:0xf bank_mask:0xf
    v_cndmask_b32_dpp v115, v121, v123, vcc row_ror:8 row_mask:0xf bank_mask:0xf
    s_waitcnt vmcnt(6)
    v_cndmask_b32_dpp v117, v124, v126, vcc row_ror:8 row_mask:0xf bank_mask:0xf
    v_cndmask_b32_dpp v121, v125, v127, vcc row_ror:8 row_mask:0xf bank_mask:0xf
    s_waitcnt vmcnt(5)
    v_cndmask_b32_dpp v119, v128, v130, vcc row_ror:8 row_mask:0xf bank_mask:0xf
    v_cndmask_b32_dpp v123, v129, v131, vcc row_ror:8 row_mask:0xf bank_mask:0xf
    s_not_b64 vcc, vcc
    v_cndmask_b32_dpp v116, v126, v124, vcc row_ror:8 row_mask:0xf bank_mask:0xf
    v_cndmask_b32_dpp v120, v127, v125, vcc row_ror:8 row_mask:0xf bank_mask:0xf
    v_cndmask_b32_dpp v118, v130, v128, vcc row_ror:8 row_mask:0xf bank_mask:0xf
    v_cndmask_b32_dpp v122, v131, v129, vcc row_ror:8 row_mask:0xf bank_mask:0xf
    s_cmp_eq_u64 s[56:57], 0
    s_cbranch_scc1 L_ml4
    s_mov_b32 s60, 0
L_ml:
    s_waitcnt vmcnt(0)
    v_xor_b32 v8, s40, v8
    v_xor_b32 v9, s41, v9
    v_xor_b32 v10, s42, v10
    v_xor_b32 v11, s46, v11
    v_or3_b32 v30, v8, v9, v10
    v_bitop3_b32 v30, v30, v11, v6 bitop3:0xa8
    v_cmp_ne_u32 vcc, 0, v30
    s_cbranch_vccz L_ml3
    global_load_dwordx4 v[8:11], v27, s[38:39] sc1
    s_add_u32 s60, s60, 1
    s_cmp_lt_u32 s60, 65536
    s_cbranch_scc1 L_ml
L_ml3:
    v_max_f32_dpp v10, v8, v8 quad_perm:[1,0,3,2] row_mask:0xf bank_mask:0xf
    s_nop 1
    v_max_f32_dpp v10, v10, v10 quad_perm:[2,3,0,1] row_mask:0xf bank_mask:0xf
    v_sub_f32 v8, v8, v10
    v_mul_f32 v8, 0x3fb8aa3b, v8
    v_exp_f32 v8, v8
    s_nop 0
    v_mul_f32 v9, v9, v8
    s_nop 1
    v_add_f32_dpp v9, v9, v9 quad_perm:[1,0,3,2] row_mask:0xf bank_mask:0xf
    s_nop 1
    v_add_f32_dpp v9, v9, v9 quad_perm:[2,3,0,1] row_mask:0xf bank_mask:0xf
    v_rcp_f32 v9, v9
    s_nop 0
    v_mul_f32 v8, v8, v9
    s_nop 1
    v_mov_b32_dpp v12, v8 quad_perm:[0,0,0,0] row_mask:0xf bank_mask:0xf
    v_mov_b32_dpp v13, v8 quad_perm:[1,1,1,1] row_mask:0xf bank_mask:0xf
    v_mov_b32_dpp v14, v8 quad_perm:[2,2,2,2] row_mask:0xf bank_mask:0xf
    v_mov_b32_dpp v15, v8 quad_perm:[3,3,3,3] row_mask:0xf bank_mask:0xf
L_ml4:
    s_mov_b32 s60, 0
    global_load_dwordx4 v[140:143], v26, s[38:39] offset:0 sc1
    global_load_dwordx4 v[144:147], v26, s[38:39] offset:512 sc1
    global_load_dwordx4 v[148:151], v26, s[38:39] offset:1024 sc1
    global_load_dwordx4 v[152:155], v26, s[38:39] offset:1536 sc1
L_op:
    s_waitcnt vmcnt(7)
    v_xor_b32 v40, s40, v40
    v_xor_b32 v41, s41, v41
    v_xor_b32 v42, s42, v42
    v_xor_b32 v43, s46, v43
    v_or3_b32 v20, v40, v41, v42
    s_waitcnt vmcnt(6)
    v_xor_b32 v44, s40, v44
    v_xor_b32 v45, s41, v45
    v_xor_b32 v46, s42, v46
    v_xor_b32 v47, s46, v47
    v_or3_b32 v20, v20, v43, v44
    v_or3_b32 v20, v20, v45, v46
    s_waitcnt vmcnt(5)
    v_xor_b32 v48, s40, v48
    v_xor_b32 v49, s41, v49
    v_xor_b32 v50, s42, v50
    v_xor_b32 v51, s46, v51
    v_or3_b32 v20, v20, v47, v48
    v_or3_b32 v20, v20, v49, v50
    s_waitcnt vmcnt(4)
    v_xor_b32 v52, s40, v52
    v_xor_b32 v53, s41, v53
    v_xor_b32 v54, s42, v54
    v_xor_b32 v55, s46, v55
    v_or3_b32 v20, v20, v51, v52
    v_or3_b32 v20, v20, v53, v54
    v_bitop3_b32 v20, v20, v55, v6 bitop3:0xa8
    v_cmp_ne_u32 vcc, 0, v20
    v_pk_mul_f32 v[16:17], v[40:41], v[12:13] op_sel_hi:[1,0]
    v_pk_mul_f32 v[18:19], v[42:43], v[12:13] op_sel_hi:[1,0]
    v_pk_fma_f32 v[16:17], v[44:45], v[12:13], v[16:17] op_sel:[0,1,0] op_sel_hi:[1,1,1]
    v_pk_fma_f32 v[18:19], v[46:47], v[12:13], v[18:19] op_sel:[0,1,0] op_sel_hi:[1,1,1]
    v_pk_fma_f32 v[16:17], v[48:49], v[14:15], v[16:17] op_sel_hi:[1,0,1]
    v_pk_fma_f32 v[18:19], v[50:51], v[14:15], v[18:19] op_sel_hi:[1,0,1]
    v_pk_fma_f32 v[16:17], v[52:53], v[14:15], v[16:17] op_sel:[0,1,0] op_sel_hi:[1,1,1]
    v_pk_fma_f32 v[18:19], v[54:55], v[14:15], v[18:19] op_sel:[0,1,0] op_sel_hi:[1,1,1]
    s_cbranch_vccz L_og
    s_mov_b64 exec, vcc
    s_add_u32 s60, s60, 1
    global_load_dwordx4 v[40:43], v26, s[38:39] offset:0 sc1
    global_load_dwordx4 v[44:47], v26, s[38:39] offset:512 sc1
    global_load_dwordx4 v[48:51], v26, s[38:39] offset:1024 sc1
    global_load_dwordx4 v[52:55], v26, s[38:39] offset:1536 sc1
    s_waitcnt vmcnt(7)
    v_xor_b32 v140, s40, v140
    v_xor_b32 v141, s41, v141
    v_xor_b32 v142, s42, v142
    v_xor_b32 v143, s46, v143
    v_or3_b32 v20, v140, v141, v142
    s_waitcnt vmcnt(6)
    v_xor_b32 v144, s40, v144
    v_xor_b32 v145, s41, v145
    v_xor_b32 v146, s42, v146
    v_xor_b32 v147, s46, v147
    v_or3_b32 v20, v20, v143, v144
    v_or3_b32 v20, v20, v145, v146
    s_waitcnt vmcnt(5)
    v_xor_b32 v148, s40, v148
    v_xor_b32 v149, s41, v149
    v_xor_b32 v150, s42, v150
    v_xor_b32 v151, s46, v151
    v_or3_b32 v20, v20, v147, v148
    v_or3_b32 v20, v20, v149, v150
    s_waitcnt vmcnt(4)
    v_xor_b32 v152, s40, v152
    v_xor_b32 v153, s41, v153
    v_xor_b32 v154, s42, v154
    v_xor_b32 v155, s46, v155
    v_or3_b32 v20, v20, v151, v152
    v_or3_b32 v20, v20, v153, v154
    v_bitop3_b32 v20, v20, v155, v6 bitop3:0xa8
    v_cmp_ne_u32 vcc, 0, v20
    v_pk_mul_f32 v[16:17], v[140:141], v[12:13] op_sel_hi:[1,0]
    v_pk_mul_f32 v[18:19], v[142:143], v[12:13] op_sel_hi:[1,0]
    v_pk_fma_f32 v[16:17], v[144:145], v[12:13], v[16:17] op_sel:[0,1,0] op_sel_hi:[1,1,1]
    v_pk_fma_f32 v[18:19], v[146:147], v[12:13], v[18:19] op_sel:[0,1,0] op_sel_hi:[1,1,1]
    v_pk_fma_f32 v[16:17], v[148:149], v[14:15], v[16:17] op_sel_hi:[1,0,1]
    v_pk_fma_f32 v[18:19], v[150:151], v[14:15], v[18:19] op_sel_hi:[1,0,1]
    v_pk_fma_f32 v[16:17], v[152:153], v[14:15], v[16:17] op_sel:[0,1,0] op_sel_hi:[1,1,1]
    v_pk_fma_f32 v[18:19], v[154:155], v[14:15], v[18:19] op_sel:[0,1,0] op_sel_hi:[1,1,1]
    s_cbranch_vccz L_og
    s_mov_b64 exec, vcc
    s_add_u32 s60, s60, 1
    global_load_dwordx4 v[140:143], v26, s[38:39] offset:0 sc1
    global_load_dwordx4 v[144:147], v26, s[38:39] offset:512 sc1
    global_load_dwordx4 v[148:151], v26, s[38:39] offset:1024 sc1
    global_load_dwordx4 v[152:155], v26, s[38:39] offset:1536 sc1
    s_cmp_lt_u32 s60, 65536
    s_cbranch_scc1 L_op
L_og:
    s_mov_b64 exec, -1
    v_cvt_pk_bf16_f32 v16, v16, v16
    v_cvt_pk_bf16_f32 v17, v17, v17
    v_cvt_pk_bf16_f32 v18, v18, v18
    v_cvt_pk_bf16_f32 v19, v19, v19
    v_and_b32_dpp v56, v16, v34 quad_perm:[0,0,0,0] row_mask:0xf bank_mask:0xf
    v_and_b32_dpp v57, v17, v34 quad_perm:[0,0,0,0] row_mask:0xf bank_mask:0xf
    v_and_b32_dpp v58, v18, v34 quad_perm:[0,0,0,0] row_mask:0xf bank_mask:0xf
    v_and_b32_dpp v59, v19, v34 quad_perm:[0,0,0,0] row_mask:0xf bank_mask:0xf
    v_and_b32_dpp v36, v16, v34 quad_perm:[1,1,1,1] row_mask:0xf bank_mask:0xf
    v_and_b32_dpp v37, v17, v34 quad_perm:[1,1,1,1] row_mask:0xf bank_mask:0xf
    v_mfma_f32_16x16x32_bf16 v[124:127], v[56:59], v[92:95], 0
    v_and_b32_dpp v38, v18, v34 quad_perm:[1,1,1,1] row_mask:0xf bank_mask:0xf
    v_mfma_f32_16x16x32_bf16 v[128:131], v[56:59], v[96:99], 0
    v_and_b32_dpp v39, v19, v34 quad_perm:[1,1,1,1] row_mask:0xf bank_mask:0xf
    v_mfma_f32_16x16x32_bf16 v[132:135], v[56:59], v[60:63], 0
    v_and_b32_dpp v20, v16, v34 quad_perm:[2,2,2,2] row_mask:0xf bank_mask:0xf
    v_mfma_f32_16x16x32_bf16 v[136:139], v[56:59], v[64:67], 0
    v_and_b32_dpp v21, v17, v34 quad_perm:[2,2,2,2] row_mask:0xf bank_mask:0xf
    v_mfma_f32_16x16x32_bf16 v[124:127], v[36:39], v[100:103], v[124:127]
    v_and_b32_dpp v22, v18, v34 quad_perm:[2,2,2,2] row_mask:0xf bank_mask:0xf
    v_mfma_f32_16x16x32_bf16 v[128:131], v[36:39], v[104:107], v[128:131]
    v_and_b32_dpp v23, v19, v34 quad_perm:[2,2,2,2] row_mask:0xf bank_mask:0xf
    v_mfma_f32_16x16x32_bf16 v[132:135], v[36:39], v[68:71], v[132:135]
    v_and_b32_dpp v56, v16, v34 quad_perm:[3,3,3,3] row_mask:0xf bank_mask:0xf
    v_mfma_f32_16x16x32_bf16 v[136:139], v[36:39], v[72:75], v[136:139]
    v_and_b32_dpp v57, v17, v34 quad_perm:[3,3,3,3] row_mask:0xf bank_mask:0xf
    v_mfma_f32_16x16x32_bf16 v[124:127], v[20:23], v[108:111], v[124:127]
    v_and_b32_dpp v58, v18, v34 quad_perm:[3,3,3,3] row_mask:0xf bank_mask:0xf
    v_mfma_f32_16x16x32_bf16 v[128:131], v[20:23], v[112:115], v[128:131]
    v_and_b32_dpp v59, v19, v34 quad_perm:[3,3,3,3] row_mask:0xf bank_mask:0xf
    v_mfma_f32_16x16x32_bf16 v[132:135], v[20:23], v[76:79], v[132:135]
    v_xor_b32 v160, s40, v160
    v_xor_b32 v161, s41, v161
    v_mfma_f32_16x16x32_bf16 v[136:139], v[20:23], v[80:83], v[136:139]
    v_xor_b32 v162, s42, v162
    v_xor_b32 v163, s46, v163
    v_mfma_f32_16x16x32_bf16 v[124:127], v[56:59], v[116:119], v[124:127]
    v_or3_b32 v30, v160, v161, v162
    v_bitop3_b32 v30, v30, v163, v6 bitop3:0xa8
    v_mfma_f32_16x16x32_bf16 v[128:131], v[56:59], v[120:123], v[128:131]
    v_cmp_ne_u32 vcc, 0, v30
    v_mfma_f32_16x16x32_bf16 v[132:135], v[56:59], v[84:87], v[132:135]
    v_mfma_f32_16x16x32_bf16 v[136:139], v[56:59], v[88:91], v[136:139]
    s_cbranch_vccnz L_sib1
L_sib2:
    s_xor_b32 s41, s41, 0x20
    v_permlane16_swap_b32 v124, v164
    v_permlane16_swap_b32 v125, v165
    s_nop 0
    v_permlane16_swap_b32 v128, v166
    v_permlane16_swap_b32 v129, v167
    s_not_b64 exec, s[62:63]
    v_pk_add_f32 v[132:133], v[132:133], v[164:165]
    v_pk_add_f32 v[134:135], v[136:137], v[166:167]
    v_bfi_b32 v132, v6, s40, v132
    v_bfi_b32 v133, v6, s41, v133
    v_bfi_b32 v134, v6, s42, v134
    v_bfi_b32 v135, v6, s52, v135
    global_store_dwordx4 v29, v[132:135], s[38:39]
    s_cmp_eq_u32 s58, 1
    s_cbranch_scc1 L_fin
    v_bfi_b32 v135, v6, s53, v135
    v_add_u32 v29, 2097152, v29
    global_store_dwordx4 v29, v[132:135], s[38:39] sc1
    s_branch L_fin
L_sib1:
    global_load_dwordx4 v[160:163], v157, s[38:39] sc1
    s_mov_b32 s60, 0
L_sib3:
    s_waitcnt vmcnt(0)
    v_xor_b32 v160, s40, v160
    v_xor_b32 v161, s41, v161
    v_xor_b32 v162, s42, v162
    v_xor_b32 v163, s46, v163
    v_or3_b32 v30, v160, v161, v162
    v_bitop3_b32 v30, v30, v163, v6 bitop3:0xa8
    v_cmp_ne_u32 vcc, 0, v30
    s_cbranch_vccz L_sib2
    global_load_dwordx4 v[160:163], v157, s[38:39] sc1
    s_add_u32 s60, s60, 1
    s_cmp_lt_u32 s60, 65536
    s_cbranch_scc1 L_sib3
    s_branch L_sib2
L_f3:
    s_lshl_b32 s13, s4, 9
    s_add_u32 s13, s13, 1441792
    s_lshl_b32 s14, s5, 4
    s_add_u32 s14, s14, s13
    v_mov_b32 v150, s14
    v_mov_b32 v152, s40
    v_mov_b32 v153, s41
    v_mov_b32 v154, s42
    v_mov_b32 v155, s47
    s_mov_b64 exec, 1
    global_store_dwordx4 v150, v[152:155], s[38:39]
    s_mov_b64 exec, -1
    v_and_b32 v150, 31, v0
    v_lshl_add_u32 v150, v150, 4, s13
    v_and_b32 v24, 2, v0
    v_lshlrev_b32 v24, 3, v24
    v_and_b32 v25, 1, v0
    v_bfe_u32 v26, v0, 4, 1
    v_lshl_add_u32 v25, v25, 1, v26
    v_bfe_u32 v26, v0, 3, 1
    v_mul_u32_u24 v26, 7, v26
    v_xor_b32 v25, v25, v26
    v_add_u32 v24, v24, v25
    v_lshrrev_b32 v25, 5, v0
    v_lshl_add_u32 v24, v25, 3, v24
    s_lshl_b32 s13, s8, 9
    s_add_u32 s13, s13, 1048576
    v_lshl_add_u32 v25, v24, 4, s13
    v_lshl_add_u32 v24, v148, 12, v25
    v_lshl_add_u32 v25, v149, 12, v25
    v_cmp_lt_u32 s[56:57], 42, v148
    v_cmp_lt_u32 s[58:59], 42, v149
    s_add_u32 s11, s11, s10
    s_lshl_b32 s13, s11, 12
    s_lshl_b32 s14, s9, 8
    s_add_u32 s13, s13, s14
    s_add_u32 s13, s13, 1048576
    v_and_b32 v26, 15, v0
    v_lshlrev_b32 v26, 4, v26
    v_lshl_add_u32 v26, v7, 9, v26
    v_add_u32 v26, s13, v26
    v_add_u32 v29, 176128, v26
    v_and_b32 v56, v40, v2
    v_and_b32 v57, v40, v3
    v_and_b32 v58, v40, v4
    v_and_b32 v59, v40, v5
    v_and_b32 v60, v41, v2
    v_and_b32 v61, v41, v3
    v_and_b32 v62, v41, v4
    v_and_b32 v63, v41, v5
    s_waitcnt vmcnt(15)
    v_mfma_f32_16x16x32_bf16 v[128:131], v[56:59], v[64:67], 0
    v_mfma_f32_16x16x32_bf16 v[136:139], v[56:59], v[96:99], 0
    v_and_b32 v56, v42, v2
    v_and_b32 v57, v42, v3
    v_and_b32 v58, v42, v4
    v_and_b32 v59, v42, v5
    v_mfma_f32_16x16x32_bf16 v[132:135], v[60:63], v[64:67], 0
    v_mfma_f32_16x16x32_bf16 v[140:143], v[60:63], v[96:99], 0
    v_and_b32 v60, v43, v2
    v_and_b32 v61, v43, v3
    v_and_b32 v62, v43, v4
    v_and_b32 v63, v43, v5
    s_waitcnt vmcnt(13)
    v_mfma_f32_16x16x32_bf16 v[128:131], v[56:59], v[68:71], v[128:131]
    v_mfma_f32_16x16x32_bf16 v[136:139], v[56:59], v[100:103], v[136:139]
    v_and_b32 v56, v44, v2
    v_and_b32 v57, v44, v3
    v_and_b32 v58, v44, v4
    v_and_b32 v59, v44, v5
    v_mfma_f32_16x16x32_bf16 v[132:135], v[60:63], v[68:71], v[132:135]
    v_mfma_f32_16x16x32_bf16 v[140:143], v[60:63], v[100:103], v[140:143]
    v_and_b32 v60, v45, v2
    v_and_b32 v61, v45, v3
    v_and_b32 v62, v45, v4
    v_and_b32 v63, v45, v5
    s_waitcnt vmcnt(11)
    v_mfma_f32_16x16x32_bf16 v[128:131], v[56:59], v[72:75], v[128:131]
    v_mfma_f32_16x16x32_bf16 v[136:139], v[56:59], v[104:107], v[136:139]
    v_and_b32 v56, v46, v2
    v_and_b32 v57, v46, v3
    v_and_b32 v58, v46, v4
    v_and_b32 v59, v46, v5
    v_mfma_f32_16x16x32_bf16 v[132:135], v[60:63], v[72:75], v[132:135]
    v_mfma_f32_16x16x32_bf16 v[140:143], v[60:63], v[104:107], v[140:143]
    v_and_b32 v60, v47, v2
    v_and_b32 v61, v47, v3
    v_and_b32 v62, v47, v4
    v_and_b32 v63, v47, v5
    s_waitcnt vmcnt(9)
    v_mfma_f32_16x16x32_bf16 v[128:131], v[56:59], v[76:79], v[128:131]
    v_mfma_f32_16x16x32_bf16 v[136:139], v[56:59], v[108:111], v[136:139]
    v_and_b32 v56, v48, v2
    v_and_b32 v57, v48, v3
    v_and_b32 v58, v48, v4
    v_and_b32 v59, v48, v5
    v_mfma_f32_16x16x32_bf16 v[132:135], v[60:63], v[76:79], v[132:135]
    v_mfma_f32_16x16x32_bf16 v[140:143], v[60:63], v[108:111], v[140:143]
    v_and_b32 v60, v49, v2
    v_and_b32 v61, v49, v3
    v_and_b32 v62, v49, v4
    v_and_b32 v63, v49, v5
    s_waitcnt vmcnt(7)
    v_mfma_f32_16x16x32_bf16 v[128:131], v[56:59], v[80:83], v[128:131]
    v_mfma_f32_16x16x32_bf16 v[136:139], v[56:59], v[112:115], v[136:139]
    v_and_b32 v56, v50, v2
    v_and_b32 v57, v50, v3
    v_and_b32 v58, v50, v4
    v_and_b32 v59, v50, v5
    v_mfma_f32_16x16x32_bf16 v[132:135], v[60:63], v[80:83], v[132:135]
    v_mfma_f32_16x16x32_bf16 v[140:143], v[60:63], v[112:115], v[140:143]
    v_and_b32 v60, v51, v2
    v_and_b32 v61, v51, v3
    v_and_b32 v62, v51, v4
    v_and_b32 v63, v51, v5
    s_waitcnt vmcnt(5)
    v_mfma_f32_16x16x32_bf16 v[128:131], v[56:59], v[84:87], v[128:131]
    v_mfma_f32_16x16x32_bf16 v[136:139], v[56:59], v[116:119], v[136:139]
    v_and_b32 v56, v52, v2
    v_and_b32 v57, v52, v3
    v_and_b32 v58, v52, v4
    v_and_b32 v59, v52, v5
    v_mfma_f32_16x16x32_bf16 v[132:135], v[60:63], v[84:87], v[132:135]
    v_mfma_f32_16x16x32_bf16 v[140:143], v[60:63], v[116:119], v[140:143]
    v_and_b32 v60, v53, v2
    v_and_b32 v61, v53, v3
    v_and_b32 v62, v53, v4
    v_and_b32 v63, v53, v5
    s_waitcnt vmcnt(3)
    v_mfma_f32_16x16x32_bf16 v[128:131], v[56:59], v[88:91], v[128:131]
    v_mfma_f32_16x16x32_bf16 v[136:139], v[56:59], v[120:123], v[136:139]
    v_and_b32 v56, v54, v2
    v_and_b32 v57, v54, v3
    v_and_b32 v58, v54, v4
    v_and_b32 v59, v54, v5
    v_mfma_f32_16x16x32_bf16 v[132:135], v[60:63], v[88:91], v[132:135]
    v_mfma_f32_16x16x32_bf16 v[140:143], v[60:63], v[120:123], v[140:143]
    v_and_b32 v60, v55, v2
    v_and_b32 v61, v55, v3
    v_and_b32 v62, v55, v4
    v_and_b32 v63, v55, v5
    s_waitcnt vmcnt(1)
    v_mfma_f32_16x16x32_bf16 v[128:131], v[56:59], v[92:95], v[128:131]
    v_mfma_f32_16x16x32_bf16 v[136:139], v[56:59], v[124:127], v[136:139]
    v_mfma_f32_16x16x32_bf16 v[132:135], v[60:63], v[92:95], v[132:135]
    v_mfma_f32_16x16x32_bf16 v[140:143], v[60:63], v[124:127], v[140:143]
    s_nop 6
    v_cndmask_b32 v128, v128, v132, s[56:57]
    v_cndmask_b32 v129, v129, v133, s[56:57]
    v_cndmask_b32 v130, v130, v134, s[56:57]
    v_cndmask_b32 v131, v131, v135, s[56:57]
    v_cndmask_b32 v136, v136, v140, s[58:59]
    v_cndmask_b32 v137, v137, v141, s[58:59]
    v_cndmask_b32 v138, v138, v142, s[58:59]
    v_cndmask_b32 v139, v139, v143, s[58:59]
    v_bfi_b32 v128, v6, s40, v128
    v_bfi_b32 v129, v6, s41, v129
    v_bfi_b32 v130, v6, s42, v130
    v_bfi_b32 v131, v6, s47, v131
    v_bfi_b32 v136, v6, s40, v136
    v_bfi_b32 v137, v6, s41, v137
    v_bfi_b32 v138, v6, s42, v138
    v_bfi_b32 v139, v6, s47, v139
    global_store_dwordx4 v24, v[128:131], s[38:39]
    s_mov_b64 exec, -1
    s_cmp_eq_u32 s12, 1
    s_cbranch_scc1 L_f4
    global_store_dwordx4 v25, v[136:139], s[38:39]
L_f4:
    v_and_b32 v20, 7, v0
    v_bfe_u32 v21, v0, 3, 1
    v_lshlrev_b32 v22, 4, v20
    v_and_b32 v23, 15, v0
    v_lshrrev_b32 v30, 5, v0
    v_lshl_add_u32 v23, v30, 4, v23
    s_cmp_ge_u32 s10, s54
    s_cbranch_scc1 L_f0
    s_mov_b32 s60, 0
    s_mov_b32 s61, 0
    s_mov_b32 s43, s47
Lp_12:
    global_load_dwordx4 v[96:99], v26, s[38:39] offset:0 sc1
    global_load_dwordx4 v[100:103], v26, s[38:39] offset:2048 sc1
    global_load_dwordx4 v[104:107], v29, s[38:39] offset:0 sc1
    global_load_dwordx4 v[108:111], v29, s[38:39] offset:2048 sc1
    global_load_dwordx4 v[8:11], v150, s[38:39] sc1
    s_add_u32 s60, s60, 1
    s_waitcnt vmcnt(0)
    v_xor_b32 v96, s40, v96
    v_xor_b32 v97, s41, v97
    v_xor_b32 v98, s42, v98
    v_xor_b32 v99, s43, v99
    v_xor_b32 v100, s40, v100
    v_xor_b32 v101, s41, v101
    v_xor_b32 v102, s42, v102
    v_xor_b32 v103, s43, v103
    v_xor_b32 v104, s40, v104
    v_xor_b32 v105, s41, v105
    v_xor_b32 v106, s42, v106
    v_xor_b32 v107, s43, v107
    v_xor_b32 v108, s40, v108
    v_xor_b32 v109, s41, v109
    v_xor_b32 v110, s42, v110
    v_xor_b32 v111, s43, v111
    v_xor_b32 v8, s40, v8
    v_xor_b32 v9, s41, v9
    v_xor_b32 v10, s42, v10
    v_xor_b32 v11, s43, v11
    v_or3_b32 v12, v96, v97, v98
    v_or3_b32 v12, v12, v99, v100
    v_or3_b32 v12, v12, v101, v102
    v_or3_b32 v12, v12, v103, v104
    v_or3_b32 v12, v12, v105, v106
    v_or3_b32 v12, v12, v107, v108
    v_or3_b32 v12, v12, v109, v110
    v_or3_b32 v12, v12, v111, v8
    v_or3_b32 v12, v12, v9, v10
    v_bitop3_b32 v12, v12, v11, v6 bitop3:0xa8
    v_cmp_ne_u32 vcc, 0, v12
    s_cbranch_vccz Lpx_13
    s_cmp_lt_u32 s60, 8
    s_cbranch_scc1 Lp_12
    s_cmp_lg_u32 s60, 8
    s_cbranch_scc1 Lpn_14
    v_bfi_b32 v131, v6, s46, v131
    v_bfi_b32 v139, v6, s46, v139
    v_add_u32 v24, 2097152, v24
    v_add_u32 v25, 2097152, v25
    v_xor_b32 v151, v150, v26
    global_store_dwordx4 v24, v[128:131], s[38:39] sc1
    s_cmp_eq_u32 s12, 1
    s_cbranch_scc1 L_f6_15
    global_store_dwordx4 v25, v[136:139], s[38:39] sc1
L_f6_15:
Lpn_14:
    s_xor_b32 s61, s61, 2097152
    s_cselect_b32 s43, s46, s47
    v_xor_b32 v26, 2097152, v26
    v_xor_b32 v29, 2097152, v29
    v_xor_b32 v150, 2097152, v150
    v_xor_b32 v150, v151, v150
    s_cmp_lt_u32 s60, 65536
    s_cbranch_scc1 Lp_12
Lpx_13:
    v_pk_add_f32 v[96:97], v[96:97], v[100:101]
    v_pk_add_f32 v[104:105], v[104:105], v[108:109]
    v_pk_add_f32 v[96:97], v[96:97], v[104:105]
    v_pk_add_f32 v[98:99], v[98:99], v[102:103]
    v_pk_add_f32 v[106:107], v[106:107], v[110:111]
    v_pk_add_f32 v[98:99], v[98:99], v[106:107]
    v_mov_b32 v100, v96
    v_mov_b32 v101, v97
    v_mov_b32 v102, v98
    v_mov_b32 v103, v99
    v_permlane32_swap_b32 v96, v100
    v_permlane32_swap_b32 v97, v101
    v_permlane32_swap_b32 v98, v102
    v_permlane32_swap_b32 v99, v103
    v_add_f32 v96, v96, v100
    v_add_f32 v97, v97, v101
    v_add_f32 v98, v98, v102
    v_add_f32 v99, v99, v103
    v_mov_b32 v100, v96
    v_mov_b32 v101, v97
    v_mov_b32 v102, v98
    v_mov_b32 v103, v99
    v_permlane16_swap_b32 v96, v100
    v_permlane16_swap_b32 v97, v101
    v_permlane16_swap_b32 v98, v102
    v_permlane16_swap_b32 v99, v103
    v_add_f32 v96, v96, v100
    v_add_f32 v97, v97, v101
    v_add_f32 v98, v98, v102
    v_add_f32 v99, v99, v103
    v_cvt_pk_bf16_f32 v97, v96, v97
    v_lshlrev_b32 v96, 16, v97
    v_and_b32 v97, 0xffff0000, v97
    v_cvt_pk_bf16_f32 v99, v98, v99
    v_lshlrev_b32 v98, 16, v99
    v_and_b32 v99, 0xffff0000, v99
    s_mov_b32 s13, 0xbdd2d3e8
    v_mov_b32 v104, 0xc0135761
    v_mul_f32 v100, v96, v96
    v_mul_f32 v101, v97, v97
    v_mul_f32 v102, v98, v98
    v_mul_f32 v103, v99, v99
    v_fma_f32 v100, v100, s13, v104
    v_fma_f32 v101, v101, s13, v104
    v_fma_f32 v102, v102, s13, v104
    v_fma_f32 v103, v103, s13, v104
    v_mul_f32 v100, v100, v96
    v_mul_f32 v101, v101, v97
    v_mul_f32 v102, v102, v98
    v_mul_f32 v103, v103, v99
    v_exp_f32 v100, v100
    v_exp_f32 v101, v101
    v_exp_f32 v102, v102
    v_exp_f32 v103, v103
    v_add_f32 v100, 1.0, v100
    v_add_f32 v101, 1.0, v101
    v_add_f32 v102, 1.0, v102
    v_add_f32 v103, 1.0, v103
    v_rcp_f32 v100, v100
    v_rcp_f32 v101, v101
    v_rcp_f32 v102, v102
    v_rcp_f32 v103, v103
    v_mul_f32 v100, v100, v96
    v_mul_f32 v101, v101, v97
    v_mul_f32 v102, v102, v98
    v_mul_f32 v103, v103, v99
    v_cvt_pk_bf16_f32 v101, v100, v101
    v_lshlrev_b32 v100, 16, v101
    v_and_b32 v101, 0xffff0000, v101
    v_cvt_pk_bf16_f32 v103, v102, v103
    v_lshlrev_b32 v102, 16, v103
    v_and_b32 v103, 0xffff0000, v103
    v_mul_f32_dpp v100, v96, v100 row_half_mirror row_mask:0xf bank_mask:0xf
    v_mul_f32_dpp v101, v97, v101 row_half_mirror row_mask:0xf bank_mask:0xf
    v_mul_f32_dpp v102, v98, v102 row_half_mirror row_mask:0xf bank_mask:0xf
    v_mul_f32_dpp v103, v99, v103 row_half_mirror row_mask:0xf bank_mask:0xf
    v_cvt_pk_bf16_f32 v100, v100, v100
    v_cvt_pk_bf16_f32 v101, v101, v101
    v_cvt_pk_bf16_f32 v102, v102, v102
    v_cvt_pk_bf16_f32 v103, v103, v103
    v_bfi_b32 v100, v6, s40, v100
    v_bfi_b32 v101, v6, s41, v101
    v_bfi_b32 v102, v6, s42, v102
    v_bfi_b32 v103, v6, s46, v103
    s_lshl1_add_u32 s13, s11, s9
    s_lshl_b32 s13, s13, 7
    s_add_u32 s13, s13, 786432
    v_lshl_add_u32 v12, v21, 6, v22
    v_add_u32 v45, s13, v12
    s_mov_b64 exec, 0x0f0f
    global_store_dwordx4 v45, v[100:103], s[38:39] sc1
    s_mov_b64 exec, -1
    s_branch L_fy
L_f0:
    s_mov_b32 s60, 0
    s_mov_b32 s61, 0
L_f01:
    global_load_dwordx4 v[8:11], v150, s[38:39] sc1
    s_add_u32 s60, s60, 1
    s_waitcnt vmcnt(0)
    v_xor_b32 v8, s40, v8
    v_xor_b32 v9, s41, v9
    v_xor_b32 v10, s42, v10
    v_xor_b32 v11, s47, v11
    v_or3_b32 v12, v8, v9, v10
    v_bitop3_b32 v12, v12, v11, v6 bitop3:0xa8
    v_cmp_ne_u32 vcc, 0, v12
    s_cbranch_vccz L_fy
    s_cmp_lt_u32 s60, 8
    s_cbranch_scc1 L_f01
    v_bfi_b32 v131, v6, s46, v131
    v_bfi_b32 v139, v6, s46, v139
    v_add_u32 v24, 2097152, v24
    v_add_u32 v25, 2097152, v25
    v_xor_b32 v151, v150, v26
    global_store_dwordx4 v24, v[128:131], s[38:39] sc1
    s_cmp_eq_u32 s12, 1
    s_cbranch_scc1 L_f6_16
    global_store_dwordx4 v25, v[136:139], s[38:39] sc1
L_f6_16:
    s_mov_b32 s61, 2097152
L_fy:
    s_or_b32 s58, s61, 1
    s_cmp_lg_u32 s61, 0
    s_cselect_b32 s59, 0, 65536
    v_mov_b32 v12, s58
    ds_write_b32 v1, v12 offset:48
    s_mul_i32 s13, s5, 3
    s_min_u32 s13, s13, 83
    s_lshl_b32 s14, s13, 14
    s_lshl_b32 s15, s4, 7
    s_add_u32 s14, s14, s15
    s_add_u32 s14, s14, 4096
    s_add_u32 s32, s32, s14
    s_addc_u32 s33, s33, 0
    v_mul_u32_u24 v24, 12288, v7
    v_lshl_add_u32 v25, v21, 10, v22
    v_add_u32 v24, v24, v25
    v_add_u32 v25, 0x2000, v24
    s_lshl_b32 s13, s13, 7
    s_add_u32 s13, s13, 786432
    v_and_b32 v26, 3, v0
    v_mad_u32_u24 v26, v7, 3, v26
    v_lshrrev_b32 v27, 2, v26
    v_and_b32 v26, 3, v26
    v_lshlrev_b32 v26, 4, v26
    v_lshl_add_u32 v26, v27, 7, v26
    v_lshl_add_u32 v26, v21, 6, v26
    v_add_u32 v26, s13, v26
    s_cmp_eq_u32 s5, 28
    s_mov_b32 s57, 0x07070707
    s_cselect_b32 s56, 0x06060000, s57
    s_lshl_b32 s13, s4, 14
    s_add_u32 s13, s13, 1572864
    s_lshl_b32 s14, s5, 9
    s_add_u32 s14, s14, s13
    v_lshl_add_u32 v31, v23, 4, s14
    s_lshl4_add_u32 s13, s5, s13
    v_lshl_add_u32 v20, v0, 9, s13
    s_lshl_b32 s13, s4, 15
    s_lshl4_add_u32 s13, s5, s13
    s_add_u32 s13, s13, 0
    v_and_b32 v21, 31, v0
    v_lshl_add_u32 v21, v21, 10, s13
    v_lshrrev_b32 v22, 5, v0
    v_lshl_add_u32 v21, v22, 3, v21
    s_xor_b32 s13, s47, 0x20
    v_mov_b32 v32, s42
    v_mov_b32 v33, s13
    s_mov_b32 exec_hi, 0
    s_xor_b32 s13, s41, 0x20
    v_mov_b32 v32, s40
    v_mov_b32 v33, s13
    s_mov_b32 exec_hi, -1
    s_lshr_b32 s13, s5, 4
    s_lshl_b32 s13, s13, 10
    s_add_u32 s13, s13, s15
    s_and_b32 s14, s5, 7
    s_lshl4_add_u32 s13, s14, s13
    s_and_b32 s14, s5, 8
    s_add_u32 s13, s13, s14
    v_lshl_add_u32 v27, v7, 1, s13
    global_load_ushort v28, v27, s[16:17]
    s_mov_b32 s52, 0x00010001
    s_mov_b32 s53, s52
    s_mov_b32 s55, 1
    s_branch L_sb
L_ret:
    s_mov_b32 s55, 0
    s_mov_b64 exec, -1
    s_nop 0
    s_mul_i32 s14, s7, 8192
    s_mul_i32 s15, s9, 2048
    s_add_u32 s14, s14, s15
    s_lshl_b32 s15, s10, 9
    s_add_u32 s14, s14, s15
    s_add_u32 s14, s14, 4198400
    v_and_b32 v12, 31, v0
    v_lshl_add_u32 v12, v12, 4, s14
    v_lshrrev_b32 v13, 5, v0
    v_lshl_add_u32 v12, v13, 11, v12
    s_mov_b32 exec_hi, 0
    global_load_dwordx4 v[140:143], v12, s[38:39] offset:-4096 sc1
    s_mov_b32 exec_hi, -1
    s_lshl_b32 s13, s4, 5
    s_add_u32 s13, s13, s5
    s_lshl_b32 s13, s13, 7
    s_add_u32 s13, s13, 1474560
    v_lshl_add_u32 v13, v0, 4, s13
    s_mov_b64 exec, 0xff
    global_load_dwordx4 v[140:143], v13, s[38:39] sc1
    s_mov_b64 exec, -1
    v_mov_b32 v148, s44
    v_mov_b32 v149, s44
    v_mov_b32 v150, s44
    v_mov_b32 v151, s44
    v_mov_b32 v8, 0
    v_mov_b32 v9, 0
    v_mov_b32 v10, 0
    v_mov_b32 v11, 0
    v_mov_b32 v16, 0
    v_mov_b32 v17, 0
    v_mov_b32 v18, 0
    v_mov_b32 v19, 0
    s_mov_b32 exec_lo, 0xffff
    s_mov_b32 exec_hi, 0xffff
    global_store_dwordx4 v31, v[8:11], s[38:39]
    s_mov_b64 exec, -1
    s_mov_b32 s60, 0
Lg_17:
    ds_read_b32 v30, v1 offset:8
    s_add_u32 s60, s60, 1
    s_waitcnt lgkmcnt(0)
    v_cmp_le_u32 vcc, 4, v30
    s_cbranch_vccnz Lgx_18
    s_sleep 1
    s_cmp_lt_u32 s60, 65536
    s_cbranch_scc1 Lg_17
Lgx_18:
    s_mov_b64 exec, 0xff
    global_store_dwordx4 v13, v[148:151], s[38:39]
    s_mov_b64 exec, -1
    s_cmp_gt_u32 s5, 28
    s_cbranch_scc1 L_yg
    global_load_dwordx4 v[68:71], v24, s[32:33] offset:-4096
    global_load_dwordx4 v[72:75], v24, s[32:33] offset:-2048
    global_load_dwordx4 v[76:79], v24, s[32:33] offset:0
    global_load_dwordx4 v[80:83], v24, s[32:33] offset:2048
    global_load_dwordx4 v[84:87], v25, s[32:33] offset:-4096
    global_load_dwordx4 v[88:91], v25, s[32:33] offset:-2048
    s_mov_b64 exec, s[56:57]
    global_load_dwordx4 v[16:19], v26, s[38:39] sc1
    s_mov_b64 exec, -1
    s_mov_b32 vcc_lo, 0xff00ff00
    s_mov_b32 vcc_hi, vcc_lo
    s_waitcnt vmcnt(6)
    v_cndmask_b32_dpp v66, v68, v70, vcc row_ror:8 row_mask:0xf bank_mask:0xf
    v_cndmask_b32_dpp v67, v69, v71, vcc row_ror:8 row_mask:0xf bank_mask:0xf
    v_mov_b32_dpp v68, v70 row_ror:8 row_mask:0xf bank_mask:0xc
    v_mov_b32_dpp v69, v71 row_ror:8 row_mask:0xf bank_mask:0xc
    s_waitcnt vmcnt(5)
    v_cndmask_b32_dpp v70, v72, v74, vcc row_ror:8 row_mask:0xf bank_mask:0xf
    v_cndmask_b32_dpp v71, v73, v75, vcc row_ror:8 row_mask:0xf bank_mask:0xf
    v_mov_b32_dpp v72, v74 row_ror:8 row_mask:0xf bank_mask:0xc
    v_mov_b32_dpp v73, v75 row_ror:8 row_mask:0xf bank_mask:0xc
    s_waitcnt vmcnt(4)
    v_cndmask_b32_dpp v74, v76, v78, vcc row_ror:8 row_mask:0xf bank_mask:0xf
    v_cndmask_b32_dpp v75, v77, v79, vcc row_ror:8 row_mask:0xf bank_mask:0xf
    v_mov_b32_dpp v76, v78 row_ror:8 row_mask:0xf bank_mask:0xc
    v_mov_b32_dpp v77, v79 row_ror:8 row_mask:0xf bank_mask:0xc
    s_waitcnt vmcnt(3)
    v_cndmask_b32_dpp v78, v80, v82, vcc row_ror:8 row_mask:0xf bank_mask:0xf
    v_cndmask_b32_dpp v79, v81, v83, vcc row_ror:8 row_mask:0xf bank_mask:0xf
    v_mov_b32_dpp v80, v82 row_ror:8 row_mask:0xf bank_mask:0xc
    v_mov_b32_dpp v81, v83 row_ror:8 row_mask:0xf bank_mask:0xc
    s_waitcnt vmcnt(2)
    v_cndmask_b32_dpp v82, v84, v86, vcc row_ror:8 row_mask:0xf bank_mask:0xf
    v_cndmask_b32_dpp v83, v85, v87, vcc row_ror:8 row_mask:0xf bank_mask:0xf
    v_mov_b32_dpp v84, v86 row_ror:8 row_mask:0xf bank_mask:0xc
    v_mov_b32_dpp v85, v87 row_ror:8 row_mask:0xf bank_mask:0xc
    s_waitcnt vmcnt(1)
    v_cndmask_b32_dpp v86, v88, v90, vcc row_ror:8 row_mask:0xf bank_mask:0xf
    v_cndmask_b32_dpp v87, v89, v91, vcc row_ror:8 row_mask:0xf bank_mask:0xf
    v_mov_b32_dpp v88, v90 row_ror:8 row_mask:0xf bank_mask:0xc
    v_mov_b32_dpp v89, v91 row_ror:8 row_mask:0xf bank_mask:0xc
    s_mov_b32 s60, 0
    s_mov_b32 s13, 0x03020302
    s_mov_b64 exec, s[56:57]
L_h:
    s_waitcnt vmcnt(0)
    v_xor_b32 v16, s40, v16
    v_xor_b32 v17, s41, v17
    v_xor_b32 v18, s42, v18
    v_xor_b32 v19, s46, v19
    v_or3_b32 v30, v16, v17, v18
    v_bitop3_b32 v30, v30, v19, v6 bitop3:0xa8
    v_cmp_ne_u32 vcc, 0, v30
    s_cbranch_vccz L_hok
    s_mov_b64 exec, vcc
    global_load_dwordx4 v[16:19], v26, s[38:39] sc1
    s_add_u32 s60, s60, 1
    s_cmp_lt_u32 s60, 65536
    s_cbranch_scc1 L_h
L_hok:
    s_mov_b64 exec, -1
    v_perm_b32 v16, v16, v16, s13
    v_perm_b32 v17, v17, v17, s13
    v_perm_b32 v18, v18, v18, s13
    v_perm_b32 v19, v19, v19, s13
    v_and_b32_dpp v56, v17, v2 quad_perm:[0,0,0,0] row_mask:0xf bank_mask:0xf
    v_and_b32_dpp v57, v17, v3 quad_perm:[0,0,0,0] row_mask:0xf bank_mask:0xf
    v_and_b32_dpp v58, v16, v2 quad_perm:[0,0,0,0] row_mask:0xf bank_mask:0xf
    v_and_b32_dpp v59, v16, v3 quad_perm:[0,0,0,0] row_mask:0xf bank_mask:0xf
    v_and_b32_dpp v60, v19, v2 quad_perm:[0,0,0,0] row_mask:0xf bank_mask:0xf
    v_and_b32_dpp v61, v19, v3 quad_perm:[0,0,0,0] row_mask:0xf bank_mask:0xf
    v_and_b32_dpp v62, v18, v2 quad_perm:[0,0,0,0] row_mask:0xf bank_mask:0xf
    v_and_b32_dpp v63, v18, v3 quad_perm:[0,0,0,0] row_mask:0xf bank_mask:0xf
    v_mfma_f32_16x16x32_bf16 v[132:135], v[56:59], v[66:69], 0
    v_and_b32_dpp v56, v17, v2 quad_perm:[1,1,1,1] row_mask:0xf bank_mask:0xf
    v_and_b32_dpp v57, v17, v3 quad_perm:[1,1,1,1] row_mask:0xf bank_mask:0xf
    v_and_b32_dpp v58, v16, v2 quad_perm:[1,1,1,1] row_mask:0xf bank_mask:0xf
    v_and_b32_dpp v59, v16, v3 quad_perm:[1,1,1,1] row_mask:0xf bank_mask:0xf
    v_mfma_f32_16x16x32_bf16 v[132:135], v[60:63], v[70:73], v[132:135]
    v_and_b32_dpp v60, v19, v2 quad_perm:[1,1,1,1] row_mask:0xf bank_mask:0xf
    v_and_b32_dpp v61, v19, v3 quad_perm:[1,1,1,1] row_mask:0xf bank_mask:0xf
    v_and_b32_dpp v62, v18, v2 quad_perm:[1,1,1,1] row_mask:0xf bank_mask:0xf
    v_and_b32_dpp v63, v18, v3 quad_perm:[1,1,1,1] row_mask:0xf bank_mask:0xf
    v_mfma_f32_16x16x32_bf16 v[132:135], v[56:59], v[74:77], v[132:135]
    v_and_b32_dpp v56, v17, v2 quad_perm:[2,2,2,2] row_mask:0xf bank_mask:0xf
    v_and_b32_dpp v57, v17, v3 quad_perm:[2,2,2,2] row_mask:0xf bank_mask:0xf
    v_and_b32_dpp v58, v16, v2 quad_perm:[2,2,2,2] row_mask:0xf bank_mask:0xf
    v_and_b32_dpp v59, v16, v3 quad_perm:[2,2,2,2] row_mask:0xf bank_mask:0xf
    v_mfma_f32_16x16x32_bf16 v[132:135], v[60:63], v[78:81], v[132:135]
    v_and_b32_dpp v60, v19, v2 quad_perm:[2,2,2,2] row_mask:0xf bank_mask:0xf
    v_and_b32_dpp v61, v19, v3 quad_perm:[2,2,2,2] row_mask:0xf bank_mask:0xf
    v_and_b32_dpp v62, v18, v2 quad_perm:[2,2,2,2] row_mask:0xf bank_mask:0xf
    v_and_b32_dpp v63, v18, v3 quad_perm:[2,2,2,2] row_mask:0xf bank_mask:0xf
    v_mfma_f32_16x16x32_bf16 v[132:135], v[56:59], v[82:85], v[132:135]
    s_nop 0
    v_mfma_f32_16x16x32_bf16 v[132:135], v[60:63], v[86:89], v[132:135]
    s_mov_b32 exec_lo, 0xffff
    s_mov_b32 exec_hi, 0xffff
    s_nop 5
    v_bfi_b32 v132, v6, s40, v132
    v_bfi_b32 v133, v6, s41, v133
    v_bfi_b32 v134, v6, s42, v134
    v_bfi_b32 v135, v6, s47, v135
    global_store_dwordx4 v31, v[132:135], s[38:39]
    s_cmp_eq_u32 s58, 1
    s_cbranch_scc1 L_yg
    v_bfi_b32 v135, v6, s46, v135
    v_add_u32 v31, 2097152, v31
    global_store_dwordx4 v31, v[132:135], s[38:39] sc1
L_yg:
    s_mov_b64 exec, -1
    s_mov_b32 s60, 0
Lg_19:
    ds_read_b32 v30, v1 offset:4
    s_add_u32 s60, s60, 1
    s_waitcnt lgkmcnt(0)
    v_cmp_le_u32 vcc, 5, v30
    s_cbranch_vccnz Lgx_20
    s_sleep 1
    s_cmp_lt_u32 s60, 65536
    s_cbranch_scc1 Lg_19
Lgx_20:
    s_mov_b64 exec, 0x1fffffff
    s_cmp_lg_u32 s58, 1
    s_cbranch_scc1 L_yslow
    s_mov_b32 s60, 0
L_yp:
    global_load_dwordx4 v[8:11], v20, s[38:39] sc1
    s_add_u32 s60, s60, 1
    s_waitcnt vmcnt(0)
    v_xor_b32 v8, s40, v8
    v_xor_b32 v9, s41, v9
    v_xor_b32 v10, s42, v10
    v_xor_b32 v11, s47, v11
    v_or3_b32 v29, v8, v9, v10
    v_bitop3_b32 v29, v29, v11, v6 bitop3:0xa8
    v_cmp_ne_u32 vcc, 0, v29
    s_cbranch_vccz L_yd
    s_mov_b64 exec, vcc
    s_cmp_lt_u32 s60, 65536
    s_cbranch_scc1 L_yp
L_yslow:
    s_mov_b32 s60, 0
    s_mov_b32 s61, 0
    s_mov_b32 s43, s47
Lp_21:
    global_load_dwordx4 v[8:11], v20, s[38:39] sc1
    s_add_u32 s60, s60, 1
    s_waitcnt vmcnt(0)
    v_xor_b32 v8, s40, v8
    v_xor_b32 v9, s41, v9
    v_xor_b32 v10, s42, v10
    v_xor_b32 v11, s43, v11
    v_or3_b32 v29, v8, v9, v10
    v_bitop3_b32 v29, v29, v11, v6 bitop3:0xa8
    v_cmp_ne_u32 vcc, 0, v29
    s_cbranch_vccz Lpx_22
    s_cmp_lt_u32 s60, s59
    s_cbranch_scc1 Lp_21
    s_xor_b32 s61, s61, 2097152
    s_cselect_b32 s43, s46, s47
    v_xor_b32 v20, 2097152, v20
    s_cmp_lt_u32 s60, 65536
    s_cbranch_scc1 Lp_21
Lpx_22:
L_yd:
    s_mov_b64 exec, -1
    global_load_dwordx2 v[12:13], v21, s[38:39] sc1
    v_permlane32_swap_b32 v8, v10
    v_permlane32_swap_b32 v9, v11
    v_add_f32 v8, v8, v10
    v_add_f32 v9, v9, v11
    s_nop 1
    v_permlane16_swap_b32 v8, v9
    v_add_f32 v8, v8, v9
    s_nop 1
    v_add_f32_dpp v8, v8, v8 row_ror:8 row_mask:0xf bank_mask:0xf
    s_nop 1
    v_add_f32_dpp v8, v8, v8 row_ror:4 row_mask:0xf bank_mask:0xf
    s_nop 1
    v_add_f32_dpp v8, v8, v8 row_ror:2 row_mask:0xf bank_mask:0xf
    s_nop 1
    v_add_f32_dpp v8, v8, v8 row_ror:1 row_mask:0xf bank_mask:0xf
    v_cvt_pk_bf16_f32 v8, v8, v8
    v_and_b32 v8, 0xffff0000, v8
    v_mul_f32 v9, 0xbfb8aa3b, v8
    v_exp_f32 v9, v9
    v_lshlrev_b32 v28, 16, v28
    v_add_f32 v9, 1.0, v9
    v_rcp_f32 v9, v9
    s_nop 0
    v_mul_f32 v16, v8, v9
    v_cvt_pk_bf16_f32 v16, v16, v16
    v_and_b32 v16, 0xffff0000, v16
    s_xor_b32 s47, s47, 0x20
    s_xor_b32 s46, s46, 0x20
    s_xor_b32 s41, s41, 0x20
    s_cmp_lg_u32 s58, 1
    s_cbranch_scc1 L_sslow
    s_mov_b32 s60, 0
    global_load_dwordx2 v[40:41], v21, s[38:39] sc1
L_sp:
    s_waitcnt vmcnt(1)
    v_xor_b32 v8, v32, v12
    v_xor_b32 v9, v33, v13
    v_bitop3_b32 v30, v8, v9, v6 bitop3:0xa8
    v_cmp_ne_u32 vcc, 0, v30
    s_cbranch_vccz L_sb
    s_mov_b64 exec, vcc
    global_load_dwordx2 v[12:13], v21, s[38:39] sc1
    s_waitcnt vmcnt(1)
    v_xor_b32 v8, v32, v40
    v_xor_b32 v9, v33, v41
    v_bitop3_b32 v30, v8, v9, v6 bitop3:0xa8
    v_cmp_ne_u32 vcc, 0, v30
    s_cbranch_vccz L_sb
    s_mov_b64 exec, vcc
    global_load_dwordx2 v[40:41], v21, s[38:39] sc1
    s_add_u32 s60, s60, 1
    s_cmp_lt_u32 s60, 65536
    s_cbranch_scc1 L_sp
L_sb:
    s_mov_b64 exec, -1
    v_permlane16_swap_b32 v8, v9
    v_add_f32 v8, v8, v9
    s_nop 1
    v_add_f32_dpp v8, v8, v8 row_ror:8 row_mask:0xf bank_mask:0xf
    s_nop 1
    v_add_f32_dpp v8, v8, v8 row_ror:4 row_mask:0xf bank_mask:0xf
    s_nop 1
    v_add_f32_dpp v8, v8, v8 row_ror:2 row_mask:0xf bank_mask:0xf
    s_nop 1
    v_add_f32_dpp v8, v8, v8 row_ror:1 row_mask:0xf bank_mask:0xf
    v_cvt_pk_bf16_f32 v8, v8, v8
    v_and_b32 v8, 0xffff0000, v8
    v_mul_f32 v8, v8, v16
    v_cvt_pk_bf16_f32 v8, v8, v8
    v_and_b32 v8, 0xffff0000, v8
    v_add_f32 v8, v8, v28
    v_cvt_pk_bf16_f32 v8, v8, v8
    s_mov_b64 exec, s[52:53]
    global_store_short v27, v8, s[34:35]
    s_cmp_lg_u32 s55, 0
    s_cbranch_scc1 L_ret
    s_cmp_lg_u32 s2, 0
    s_cbranch_scc1 L_fe
    s_mov_b64 exec, 1
    v_mov_b32 v34, s44
    v_mov_b32 v35, 263040
    global_store_dword v35, v34, s[38:39]
L_fe:
    s_endpgm
L_sslow:
    s_mov_b32 exec_lo, -1
    s_mov_b32 exec_hi, 0
    s_mov_b32 s60, 0
    s_mov_b32 s61, 0
    s_mov_b32 s43, s47
Lp_24:
    global_load_dwordx4 v[8:11], v21, s[38:39] sc1
    s_add_u32 s60, s60, 1
    s_waitcnt vmcnt(0)
    v_xor_b32 v8, s40, v8
    v_xor_b32 v9, s41, v9
    v_xor_b32 v10, s42, v10
    v_xor_b32 v11, s43, v11
    v_or3_b32 v30, v8, v9, v10
    v_bitop3_b32 v30, v30, v11, v6 bitop3:0xa8
    v_cmp_ne_u32 vcc, 0, v30
    s_cbranch_vccz Lpx_25
    s_cmp_lt_u32 s60, s59
    s_cbranch_scc1 Lp_24
    s_xor_b32 s61, s61, 2097152
    s_cselect_b32 s43, s46, s47
    v_xor_b32 v21, 2097152, v21
    s_cmp_lt_u32 s60, 65536
    s_cbranch_scc1 Lp_24
Lpx_25:
    s_mov_b64 exec, -1
    v_permlane32_swap_b32 v8, v10
    v_permlane32_swap_b32 v9, v11
    s_nop 0
    s_branch L_sb
L_kv:
    v_mov_b32 v1, 0
    v_lshlrev_b32 v8, 2, v0
    ds_write_b32 v8, v1
    v_lshlrev_b32 v8, 4, v0
    s_add_u32 s28, s20, s14
    s_addc_u32 s29, s21, 0
    s_mov_b32 s30, s54
    s_mov_b32 s31, s55
    s_mul_i32 s14, s7, 8192
    s_mul_i32 s15, s9, 2048
    s_add_u32 s14, s14, s15
    s_lshl_b32 s15, s10, 9
    s_add_u32 s14, s14, s15
    s_add_u32 s14, s14, 4198400
    s_add_u32 s56, s38, s14
    s_addc_u32 s57, s39, 0
    s_mov_b32 s11, s12
    v_and_b32 v6, 3, v0
    v_lshlrev_b32 v6, 4, v6
    v_mov_b32 v2, 0xffff
    v_mov_b32 v3, 0
    v_lshlrev_b64 v[2:3], v6, v[2:3]
    s_mov_b32 s62, 0xf0f0f0f0
    s_mov_b32 s63, s62
    v_cndmask_b32 v4, 0, v2, s[62:63]
    v_cndmask_b32 v5, 0, v3, s[62:63]
    v_cndmask_b32 v2, v2, 0, s[62:63]
    v_cndmask_b32 v3, v3, 0, s[62:63]
    v_mov_b32 v6, 0xff
    s_waitcnt lgkmcnt(0)
    s_barrier
    s_load_dword s44, s[38:39], 263040
    buffer_load_dwordx4 v[40:43], v9, s[52:55], s12 offen offset:2048 nt
    buffer_load_dwordx4 v[44:47], v9, s[52:55], s12 offen offset:3072 nt
    s_addk_i32 s12, 0x1000
    s_bitset0_b32 s12, 14
    s_waitcnt vmcnt(3)
    buffer_load_dwordx4 v[48:51], v9, s[52:55], s12 offen offset:0 nt
    s_waitcnt vmcnt(3)
    buffer_load_dwordx4 v[52:55], v9, s[52:55], s12 offen offset:1024 nt
    s_waitcnt vmcnt(3)
    buffer_load_dwordx4 v[56:59], v9, s[52:55], s12 offen offset:2048 nt
    s_waitcnt vmcnt(3)
    buffer_load_dwordx4 v[60:63], v9, s[52:55], s12 offen offset:3072 nt
    s_addk_i32 s12, 0x1000
    s_bitset0_b32 s12, 14
    s_waitcnt vmcnt(5)
    buffer_load_dwordx4 v[64:67], v9, s[52:55], s12 offen offset:0 nt
    s_waitcnt vmcnt(5)
    buffer_load_dwordx4 v[68:71], v9, s[52:55], s12 offen offset:1024 nt
    s_waitcnt vmcnt(5)
    buffer_load_dwordx4 v[72:75], v9, s[52:55], s12 offen offset:2048 nt
    s_waitcnt vmcnt(5)
    buffer_load_dwordx4 v[76:79], v9, s[52:55], s12 offen offset:3072 nt
    s_addk_i32 s12, 0x1000
    s_bitset0_b32 s12, 14
    s_waitcnt vmcnt(5)
    buffer_load_dwordx4 v[80:83], v9, s[52:55], s12 offen offset:0 nt
    s_waitcnt vmcnt(5)
    buffer_load_dwordx4 v[84:87], v9, s[52:55], s12 offen offset:1024 nt
    s_waitcnt vmcnt(5)
    buffer_load_dwordx4 v[88:91], v9, s[52:55], s12 offen offset:2048 nt
    s_waitcnt vmcnt(5)
    buffer_load_dwordx4 v[92:95], v9, s[52:55], s12 offen offset:3072 nt
    s_waitcnt vmcnt(6)
    buffer_load_dwordx4 v[96:99], v8, s[28:31], s11 offen offset:0 nt
    s_waitcnt vmcnt(6)
    buffer_load_dwordx4 v[100:103], v8, s[28:31], s11 offen offset:1024 nt
    s_waitcnt vmcnt(6)
    buffer_load_dwordx4 v[104:107], v8, s[28:31], s11 offen offset:2048 nt
    s_waitcnt vmcnt(6)
    buffer_load_dwordx4 v[108:111], v8, s[28:31], s11 offen offset:3072 nt
    s_addk_i32 s11, 0x1000
    s_bitset0_b32 s11, 14
    s_waitcnt vmcnt(6)
    buffer_load_dwordx4 v[112:115], v8, s[28:31], s11 offen offset:0 nt
    s_waitcnt vmcnt(6)
    buffer_load_dwordx4 v[116:119], v8, s[28:31], s11 offen offset:1024 nt
    s_waitcnt vmcnt(6)
    buffer_load_dwordx4 v[120:123], v8, s[28:31], s11 offen offset:2048 nt
    s_waitcnt vmcnt(6)
    buffer_load_dwordx4 v[124:127], v8, s[28:31], s11 offen offset:3072 nt
    s_addk_i32 s11, 0x1000
    s_bitset0_b32 s11, 14
    s_waitcnt vmcnt(6)
    buffer_load_dwordx4 v[128:131], v8, s[28:31], s11 offen offset:0 nt
    s_mov_b32 s60, 0
L_kq:
    ds_read_b32 v9, v1 offset:0
    ds_read_b128 v[12:15], v164 offset:64
    s_add_u32 s60, s60, 1
    s_waitcnt lgkmcnt(0)
    v_readfirstlane_b32 s58, v9
    s_cmp_lg_u32 s58, 0
    s_cbranch_scc1 L_kq2
    s_sleep 1
    s_cmp_lt_u32 s60, 65536
    s_cbranch_scc1 L_kq
L_kq2:
    s_waitcnt vmcnt(9)
    s_mov_b32 s62, 0xf000f
    s_mov_b32 s63, s62
    v_cndmask_b32 v160, 0, v12, s[62:63]
    v_cndmask_b32 v161, 0, v13, s[62:63]
    v_cndmask_b32 v162, 0, v14, s[62:63]
    v_cndmask_b32 v163, 0, v15, s[62:63]
    s_nop 1
    v_mfma_f32_16x16x32_bf16 v[16:19], v[32:35], v[160:163], 0
    v_mfma_f32_16x16x32_bf16 v[20:23], v[48:51], v[160:163], 0
    v_mfma_f32_16x16x32_bf16 v[24:27], v[64:67], v[160:163], 0
    v_mfma_f32_16x16x32_bf16 v[28:31], v[80:83], v[160:163], 0
    s_mov_b32 s62, 0xf000f0
    s_mov_b32 s63, s62
    v_cndmask_b32 v164, 0, v12, s[62:63]
    v_cndmask_b32 v165, 0, v13, s[62:63]
    v_cndmask_b32 v166, 0, v14, s[62:63]
    v_cndmask_b32 v167, 0, v15, s[62:63]
    s_nop 1
    v_mfma_f32_16x16x32_bf16 v[16:19], v[36:39], v[164:167], v[16:19]
    v_mfma_f32_16x16x32_bf16 v[20:23], v[52:55], v[164:167], v[20:23]
    v_mfma_f32_16x16x32_bf16 v[24:27], v[68:71], v[164:167], v[24:27]
    v_mfma_f32_16x16x32_bf16 v[28:31], v[84:87], v[164:167], v[28:31]
    s_mov_b32 s62, 0xf000f00
    s_mov_b32 s63, s62
    v_cndmask_b32 v160, 0, v12, s[62:63]
    v_cndmask_b32 v161, 0, v13, s[62:63]
    v_cndmask_b32 v162, 0, v14, s[62:63]
    v_cndmask_b32 v163, 0, v15, s[62:63]
    s_nop 1
    v_mfma_f32_16x16x32_bf16 v[16:19], v[40:43], v[160:163], v[16:19]
    v_mfma_f32_16x16x32_bf16 v[20:23], v[56:59], v[160:163], v[20:23]
    v_mfma_f32_16x16x32_bf16 v[24:27], v[72:75], v[160:163], v[24:27]
    v_mfma_f32_16x16x32_bf16 v[28:31], v[88:91], v[160:163], v[28:31]
    s_mov_b32 s62, 0xf000f000
    s_mov_b32 s63, s62
    v_cndmask_b32 v164, 0, v12, s[62:63]
    v_cndmask_b32 v165, 0, v13, s[62:63]
    v_cndmask_b32 v166, 0, v14, s[62:63]
    v_cndmask_b32 v167, 0, v15, s[62:63]
    s_nop 1
    v_mfma_f32_16x16x32_bf16 v[16:19], v[44:47], v[164:167], v[16:19]
    v_mfma_f32_16x16x32_bf16 v[20:23], v[60:63], v[164:167], v[20:23]
    v_mfma_f32_16x16x32_bf16 v[24:27], v[76:79], v[164:167], v[24:27]
    v_mfma_f32_16x16x32_bf16 v[28:31], v[92:95], v[164:167], v[28:31]
    s_add_u32 s44, s44, 0x01010101
    s_or_b32 s44, s44, 0x80808080
    s_and_b32 s40, s44, 0xff
    s_bfe_u32 s41, s44, 0x80008
    s_bfe_u32 s42, s44, 0x80010
    s_lshr_b32 s46, s44, 24
    s_lshl_b32 s14, s13, 3
    v_mov_b32 v11, s14
    v_mov_b32_dpp v12, v16 quad_perm:[0,0,0,0] row_mask:0xf bank_mask:0xf
    v_mov_b32_dpp v13, v20 quad_perm:[0,0,0,0] row_mask:0xf bank_mask:0xf
    v_mov_b32_dpp v14, v24 quad_perm:[0,0,0,0] row_mask:0xf bank_mask:0xf
    v_mov_b32_dpp v15, v28 quad_perm:[0,0,0,0] row_mask:0xf bank_mask:0xf
    v_add_f32_dpp v12, v17, v12 quad_perm:[1,1,1,1] row_mask:0xf bank_mask:0xf
    v_add_f32_dpp v13, v21, v13 quad_perm:[1,1,1,1] row_mask:0xf bank_mask:0xf
    v_add_f32_dpp v14, v25, v14 quad_perm:[1,1,1,1] row_mask:0xf bank_mask:0xf
    v_add_f32_dpp v15, v29, v15 quad_perm:[1,1,1,1] row_mask:0xf bank_mask:0xf
    v_add_f32_dpp v12, v18, v12 quad_perm:[2,2,2,2] row_mask:0xf bank_mask:0xf
    v_add_f32_dpp v13, v22, v13 quad_perm:[2,2,2,2] row_mask:0xf bank_mask:0xf
    v_add_f32_dpp v14, v26, v14 quad_perm:[2,2,2,2] row_mask:0xf bank_mask:0xf
    v_add_f32_dpp v15, v30, v15 quad_perm:[2,2,2,2] row_mask:0xf bank_mask:0xf
    v_add_f32_dpp v12, v19, v12 quad_perm:[3,3,3,3] row_mask:0xf bank_mask:0xf
    v_add_f32_dpp v13, v23, v13 quad_perm:[3,3,3,3] row_mask:0xf bank_mask:0xf
    v_add_f32_dpp v14, v27, v14 quad_perm:[3,3,3,3] row_mask:0xf bank_mask:0xf
    v_add_f32_dpp v15, v31, v15 quad_perm:[3,3,3,3] row_mask:0xf bank_mask:0xf
    v_cvt_pk_bf16_f32 v13, v12, v13
    v_lshlrev_b32 v12, 16, v13
    v_and_b32 v13, 0xffff0000, v13
    v_cvt_pk_bf16_f32 v15, v14, v15
    v_lshlrev_b32 v14, 16, v15
    v_and_b32 v15, 0xffff0000, v15
    v_mul_f32 v12, 0x3db504f3, v12
    v_mul_f32 v13, 0x3db504f3, v13
    v_mul_f32 v14, 0x3db504f3, v14
    v_mul_f32 v15, 0x3db504f3, v15
    v_cvt_pk_bf16_f32 v13, v12, v13
    v_lshlrev_b32 v12, 16, v13
    v_and_b32 v13, 0xffff0000, v13
    v_cvt_pk_bf16_f32 v15, v14, v15
    v_lshlrev_b32 v14, 16, v15
    v_and_b32 v15, 0xffff0000, v15
    v_max3_f32 v16, v12, v13, v14
    v_max_f32 v16, v16, v15
    s_nop 1
    v_max_f32_dpp v16, v16, v16 row_ror:4 row_mask:0xf bank_mask:0xf
    s_nop 1
    v_max_f32_dpp v16, v16, v16 row_ror:8 row_mask:0xf bank_mask:0xf
    v_mov_b32 v18, v16
    s_nop 1
    v_permlane16_swap_b32 v16, v18
    v_max_f32 v16, v16, v18
    v_mov_b32 v18, v16
    s_nop 1
    v_permlane32_swap_b32 v16, v18
    v_max_f32 v16, v16, v18
    v_sub_f32 v12, v12, v16
    v_sub_f32 v13, v13, v16
    v_sub_f32 v14, v14, v16
    v_sub_f32 v15, v15, v16
    v_mul_f32 v12, 0x3fb8aa3b, v12
    v_mul_f32 v13, 0x3fb8aa3b, v13
    v_mul_f32 v14, 0x3fb8aa3b, v14
    v_mul_f32 v15, 0x3fb8aa3b, v15
    v_exp_f32 v12, v12
    v_exp_f32 v13, v13
    v_exp_f32 v14, v14
    v_exp_f32 v15, v15
    v_add_f32 v17, v12, v13
    v_add_f32 v18, v14, v15
    v_add_f32 v17, v17, v18
    v_cvt_pk_bf16_f32 v12, v12, v12
    v_cvt_pk_bf16_f32 v13, v13, v13
    v_cvt_pk_bf16_f32 v14, v14, v14
    v_cvt_pk_bf16_f32 v15, v15, v15
    v_add_f32_dpp v17, v17, v17 row_ror:4 row_mask:0xf bank_mask:0xf
    s_nop 1
    v_add_f32_dpp v17, v17, v17 row_ror:8 row_mask:0xf bank_mask:0xf
    v_mov_b32 v18, v17
    s_nop 1
    v_permlane16_swap_b32 v17, v18
    v_add_f32 v17, v17, v18
    v_mov_b32 v18, v17
    s_nop 1
    v_permlane32_swap_b32 v17, v18
    v_add_f32 v17, v17, v18
    s_mov_b64 exec, 1
    ds_write_b64 v11, v[16:17] offset:16
    s_mov_b64 exec, -1
    s_waitcnt vmcnt(6)
    buffer_load_dwordx4 v[132:135], v8, s[28:31], s11 offen offset:1024 nt
    v_and_b32_dpp v32, v12, v2 row_newbcast:0 row_mask:0xf bank_mask:0xf
    v_and_b32_dpp v33, v12, v3 row_newbcast:0 row_mask:0xf bank_mask:0xf
    v_and_b32_dpp v34, v12, v4 row_newbcast:0 row_mask:0xf bank_mask:0xf
    v_and_b32_dpp v35, v12, v5 row_newbcast:0 row_mask:0xf bank_mask:0xf
    v_and_b32_dpp v36, v12, v2 row_newbcast:4 row_mask:0xf bank_mask:0xf
    v_and_b32_dpp v37, v12, v3 row_newbcast:4 row_mask:0xf bank_mask:0xf
    v_and_b32_dpp v38, v12, v4 row_newbcast:4 row_mask:0xf bank_mask:0xf
    v_and_b32_dpp v39, v12, v5 row_newbcast:4 row_mask:0xf bank_mask:0xf
    v_and_b32_dpp v40, v12, v2 row_newbcast:8 row_mask:0xf bank_mask:0xf
    v_and_b32_dpp v41, v12, v3 row_newbcast:8 row_mask:0xf bank_mask:0xf
    v_and_b32_dpp v42, v12, v4 row_newbcast:8 row_mask:0xf bank_mask:0xf
    v_and_b32_dpp v43, v12, v5 row_newbcast:8 row_mask:0xf bank_mask:0xf
    v_mfma_f32_16x16x32_bf16 v[20:23], v[32:35], v[96:99], 0
    v_mfma_f32_16x16x32_bf16 v[20:23], v[36:39], v[100:103], v[20:23]
    v_mfma_f32_16x16x32_bf16 v[20:23], v[40:43], v[104:107], v[20:23]
    s_waitcnt vmcnt(6)
    buffer_load_dwordx4 v[136:139], v8, s[28:31], s11 offen offset:2048 nt
    v_and_b32_dpp v44, v12, v2 row_newbcast:12 row_mask:0xf bank_mask:0xf
    v_and_b32_dpp v45, v12, v3 row_newbcast:12 row_mask:0xf bank_mask:0xf
    v_and_b32_dpp v46, v12, v4 row_newbcast:12 row_mask:0xf bank_mask:0xf
    v_and_b32_dpp v47, v12, v5 row_newbcast:12 row_mask:0xf bank_mask:0xf
    v_and_b32_dpp v48, v13, v2 row_newbcast:0 row_mask:0xf bank_mask:0xf
    v_and_b32_dpp v49, v13, v3 row_newbcast:0 row_mask:0xf bank_mask:0xf
    v_and_b32_dpp v50, v13, v4 row_newbcast:0 row_mask:0xf bank_mask:0xf
    v_and_b32_dpp v51, v13, v5 row_newbcast:0 row_mask:0xf bank_mask:0xf
    v_and_b32_dpp v52, v13, v2 row_newbcast:4 row_mask:0xf bank_mask:0xf
    v_and_b32_dpp v53, v13, v3 row_newbcast:4 row_mask:0xf bank_mask:0xf
    v_and_b32_dpp v54, v13, v4 row_newbcast:4 row_mask:0xf bank_mask:0xf
    v_and_b32_dpp v55, v13, v5 row_newbcast:4 row_mask:0xf bank_mask:0xf
    v_mfma_f32_16x16x32_bf16 v[20:23], v[44:47], v[108:111], v[20:23]
    s_waitcnt vmcnt(6)
    buffer_load_dwordx4 v[140:143], v8, s[28:31], s11 offen offset:3072 nt
    s_addk_i32 s11, 0x1000
    s_bitset0_b32 s11, 14
    v_and_b32_dpp v56, v13, v2 row_newbcast:8 row_mask:0xf bank_mask:0xf
    v_and_b32_dpp v57, v13, v3 row_newbcast:8 row_mask:0xf bank_mask:0xf
    v_and_b32_dpp v58, v13, v4 row_newbcast:8 row_mask:0xf bank_mask:0xf
    v_and_b32_dpp v59, v13, v5 row_newbcast:8 row_mask:0xf bank_mask:0xf
    v_and_b32_dpp v60, v13, v2 row_newbcast:12 row_mask:0xf bank_mask:0xf
    v_and_b32_dpp v61, v13, v3 row_newbcast:12 row_mask:0xf bank_mask:0xf
    v_and_b32_dpp v62, v13, v4 row_newbcast:12 row_mask:0xf bank_mask:0xf
    v_and_b32_dpp v63, v13, v5 row_newbcast:12 row_mask:0xf bank_mask:0xf
    v_mfma_f32_16x16x32_bf16 v[20:23], v[48:51], v[112:115], v[20:23]
    s_waitcnt vmcnt(6)
    buffer_load_dwordx4 v[144:147], v8, s[28:31], s11 offen offset:0 nt
    v_and_b32_dpp v64, v14, v2 row_newbcast:0 row_mask:0xf bank_mask:0xf
    v_and_b32_dpp v65, v14, v3 row_newbcast:0 row_mask:0xf bank_mask:0xf
    v_and_b32_dpp v66, v14, v4 row_newbcast:0 row_mask:0xf bank_mask:0xf
    v_and_b32_dpp v67, v14, v5 row_newbcast:0 row_mask:0xf bank_mask:0xf
    v_and_b32_dpp v68, v14, v2 row_newbcast:4 row_mask:0xf bank_mask:0xf
    v_and_b32_dpp v69, v14, v3 row_newbcast:4 row_mask:0xf bank_mask:0xf
    v_and_b32_dpp v70, v14, v4 row_newbcast:4 row_mask:0xf bank_mask:0xf
    v_and_b32_dpp v71, v14, v5 row_newbcast:4 row_mask:0xf bank_mask:0xf
    v_mfma_f32_16x16x32_bf16 v[20:23], v[52:55], v[116:119], v[20:23]
    s_waitcnt vmcnt(6)
    buffer_load_dwordx4 v[148:151], v8, s[28:31], s11 offen offset:1024 nt
    v_and_b32_dpp v72, v14, v2 row_newbcast:8 row_mask:0xf bank_mask:0xf
    v_and_b32_dpp v73, v14, v3 row_newbcast:8 row_mask:0xf bank_mask:0xf
    v_and_b32_dpp v74, v14, v4 row_newbcast:8 row_mask:0xf bank_mask:0xf
    v_and_b32_dpp v75, v14, v5 row_newbcast:8 row_mask:0xf bank_mask:0xf
    v_and_b32_dpp v76, v14, v2 row_newbcast:12 row_mask:0xf bank_mask:0xf
    v_and_b32_dpp v77, v14, v3 row_newbcast:12 row_mask:0xf bank_mask:0xf
    v_and_b32_dpp v78, v14, v4 row_newbcast:12 row_mask:0xf bank_mask:0xf
    v_and_b32_dpp v79, v14, v5 row_newbcast:12 row_mask:0xf bank_mask:0xf
    v_mfma_f32_16x16x32_bf16 v[20:23], v[56:59], v[120:123], v[20:23]
    s_waitcnt vmcnt(6)
    buffer_load_dwordx4 v[152:155], v8, s[28:31], s11 offen offset:2048 nt
    v_and_b32_dpp v80, v15, v2 row_newbcast:0 row_mask:0xf bank_mask:0xf
    v_and_b32_dpp v81, v15, v3 row_newbcast:0 row_mask:0xf bank_mask:0xf
    v_and_b32_dpp v82, v15, v4 row_newbcast:0 row_mask:0xf bank_mask:0xf
    v_and_b32_dpp v83, v15, v5 row_newbcast:0 row_mask:0xf bank_mask:0xf
    v_and_b32_dpp v84, v15, v2 row_newbcast:4 row_mask:0xf bank_mask:0xf
    v_and_b32_dpp v85, v15, v3 row_newbcast:4 row_mask:0xf bank_mask:0xf
    v_and_b32_dpp v86, v15, v4 row_newbcast:4 row_mask:0xf bank_mask:0xf
    v_and_b32_dpp v87, v15, v5 row_newbcast:4 row_mask:0xf bank_mask:0xf
    v_mfma_f32_16x16x32_bf16 v[20:23], v[60:63], v[124:127], v[20:23]
    s_waitcnt vmcnt(6)
    buffer_load_dwordx4 v[156:159], v8, s[28:31], s11 offen offset:3072 nt
    v_mov_b32 v10, 1
    s_mov_b64 exec, 1
    ds_add_u32 v1, v10 offset:8
    s_mov_b64 exec, -1
    v_and_b32_dpp v88, v15, v2 row_newbcast:8 row_mask:0xf bank_mask:0xf
    v_and_b32_dpp v89, v15, v3 row_newbcast:8 row_mask:0xf bank_mask:0xf
    v_and_b32_dpp v90, v15, v4 row_newbcast:8 row_mask:0xf bank_mask:0xf
    v_and_b32_dpp v91, v15, v5 row_newbcast:8 row_mask:0xf bank_mask:0xf
    v_and_b32_dpp v92, v15, v2 row_newbcast:12 row_mask:0xf bank_mask:0xf
    v_and_b32_dpp v93, v15, v3 row_newbcast:12 row_mask:0xf bank_mask:0xf
    v_and_b32_dpp v94, v15, v4 row_newbcast:12 row_mask:0xf bank_mask:0xf
    v_and_b32_dpp v95, v15, v5 row_newbcast:12 row_mask:0xf bank_mask:0xf
    v_mfma_f32_16x16x32_bf16 v[20:23], v[64:67], v[128:131], v[20:23]
    v_and_b32 v18, 3, v0
    v_lshlrev_b32 v18, 3, v18
    s_mov_b32 s60, 0
L_km:
    ds_read_b64 v[24:25], v18 offset:16
    s_add_u32 s60, s60, 1
    s_waitcnt lgkmcnt(0)
    v_cmp_eq_u32 vcc, 0, v25
    s_cbranch_vccz L_km2
    s_cmp_lt_u32 s60, 65536
    s_cbranch_scc1 L_km
L_km2:
    v_max_f32_dpp v24, v24, v24 quad_perm:[1,0,3,2] row_mask:0xf bank_mask:0xf
    v_and_b32 v18, 15, v0
    v_lshl_add_u32 v18, v18, 1, v7
    v_max_f32_dpp v24, v24, v24 quad_perm:[2,3,0,1] row_mask:0xf bank_mask:0xf
    v_sub_f32 v16, v16, v24
    v_mul_f32 v16, 0x3fb8aa3b, v16
    v_exp_f32 v16, v16
    v_lshlrev_b32 v18, 4, v18
    s_lshl_b32 s14, s13, 9
    v_add_u32 v18, s14, v18
    v_mov_b32 v19, 1
    v_xor_b32 v26, 0x200, v18
    v_xor_b32 v27, 0x400, v18
    v_xor_b32 v28, 0x600, v18
    v_and_b32 v25, 0x1ff, v18
    v_mov_b32 v29, 2
    s_waitcnt vmcnt(6)
    v_mfma_f32_16x16x32_bf16 v[20:23], v[68:71], v[132:135], v[20:23]
    s_waitcnt vmcnt(5)
    v_mfma_f32_16x16x32_bf16 v[20:23], v[72:75], v[136:139], v[20:23]
    s_waitcnt vmcnt(4)
    v_mfma_f32_16x16x32_bf16 v[20:23], v[76:79], v[140:143], v[20:23]
    s_waitcnt vmcnt(3)
    v_mfma_f32_16x16x32_bf16 v[20:23], v[80:83], v[144:147], v[20:23]
    s_waitcnt vmcnt(2)
    v_mfma_f32_16x16x32_bf16 v[20:23], v[84:87], v[148:151], v[20:23]
    s_waitcnt vmcnt(1)
    v_mfma_f32_16x16x32_bf16 v[20:23], v[88:91], v[152:155], v[20:23]
    s_mov_b32 exec_hi, 0
    ds_read_b32 v24, v1 offset:4
    ds_read_b128 v[36:39], v27 offset:512
    ds_read_b128 v[40:43], v28 offset:512
    ds_read_b128 v[32:35], v26 offset:512
    s_mov_b32 exec_hi, -1
    s_waitcnt vmcnt(0)
    v_mfma_f32_16x16x32_bf16 v[20:23], v[92:95], v[156:159], v[20:23]
    s_mov_b32 exec_hi, 0
    s_waitcnt lgkmcnt(1)
    v_readfirstlane_b32 s45, v24
    v_pk_add_f32 v[36:37], v[36:37], v[40:41]
    v_pk_add_f32 v[38:39], v[38:39], v[42:43]
    s_cmp_eq_u32 s45, 3
    s_nop 1
    v_pk_mul_f32 v[20:21], v[20:21], v[16:17] op_sel_hi:[1,0]
    v_pk_mul_f32 v[22:23], v[22:23], v[16:17] op_sel_hi:[1,0]
    s_cbranch_scc0 L_kslow
    s_waitcnt lgkmcnt(0)
    v_pk_add_f32 v[20:21], v[20:21], v[32:33]
    v_pk_add_f32 v[22:23], v[22:23], v[34:35]
    v_pk_add_f32 v[20:21], v[20:21], v[36:37]
    v_pk_add_f32 v[22:23], v[22:23], v[38:39]
    v_bfi_b32 v20, v6, s40, v20
    v_bfi_b32 v21, v6, s41, v21
    v_bfi_b32 v22, v6, s42, v22
    v_bfi_b32 v23, v6, s46, v23
    global_store_dwordx4 v25, v[20:23], s[56:57] offset:-4096 sc1
    s_mov_b32 exec_lo, 1
    ds_add_u32 v1, v29 offset:4
    s_branch L_fin
L_kslow:
    ds_write_b128 v18, v[20:23] offset:512
    s_mov_b32 exec_lo, 1
    ds_add_rtn_u32 v24, v1, v19 offset:4
    s_mov_b32 exec_lo, -1
    ds_read_b128 v[68:71], v8 offset:512
    ds_read_b128 v[72:75], v8 offset:1024
    ds_read_b128 v[76:79], v8 offset:1536
    ds_read_b128 v[80:83], v8 offset:2048
    s_waitcnt lgkmcnt(2)
    v_readfirstlane_b32 s45, v24
    v_pk_add_f32 v[68:69], v[68:69], v[72:73]
    v_pk_add_f32 v[70:71], v[70:71], v[74:75]
    s_cmp_lg_u32 s45, 3
    s_cbranch_scc1 L_fin
    s_waitcnt lgkmcnt(0)
    v_pk_add_f32 v[76:77], v[76:77], v[80:81]
    v_pk_add_f32 v[78:79], v[78:79], v[82:83]
    v_pk_add_f32 v[68:69], v[68:69], v[76:77]
    v_pk_add_f32 v[70:71], v[70:71], v[78:79]
    v_bfi_b32 v68, v6, s40, v68
    v_bfi_b32 v69, v6, s41, v69
    v_bfi_b32 v70, v6, s42, v70
    v_bfi_b32 v71, v6, s46, v71
    global_store_dwordx4 v8, v[68:71], s[56:57] offset:-4096 sc1
    s_mov_b32 exec_lo, 1
    ds_add_u32 v1, v19 offset:4
L_fin:
L_end:
    s_endpgm
L_codeend:
.fill (13828-(L_codeend-L_pc))/4, 4, 0
L_tab:
.long 0x3020100, 0x10200
.long 0x2f2e2f2e, 0x20101
.long 0x2d2c0504, 0x10203
.long 0x302b302b, 0x1020104
.long 0x9080706, 0x10206
.long 0x35343534, 0x20107
.long 0x33320b0a, 0x10209
.long 0x36313631, 0x102010a
.long 0xf0e0d0c, 0x1020c
.long 0x3b3a3b3a, 0x2010d
.long 0x39381110, 0x1020f
.long 0x3c373c37, 0x1020110
.long 0x13121312, 0x20112
.long 0x15141514, 0x20114
.long 0x3d163d16, 0x1010116
.long 0x41403f3e, 0x200
.long 0x19181918, 0x20117
.long 0x1b1a1b1a, 0x20119
.long 0x46174617, 0x101011b
.long 0x45444342, 0x200
.long 0x1d1c1d1c, 0x2011c
.long 0x1f1e1f1e, 0x2011e
.long 0x47204720, 0x1010120
.long 0x4b4a4948, 0x200
.long 0x23222322, 0x20121
.long 0x25242524, 0x20123
.long 0x50215021, 0x1010125
.long 0x4f4e4d4c, 0x200
.long 0x27262726, 0x20126
.long 0x29282928, 0x20128
.long 0x512a512a, 0x101012a
.long 0x55545352, 0x200
.section .rodata,"a"
.p2align 6
.amdhsa_kernel recurrent_scan__sliding_block_cached__glu_gated_geglu__decode_kernel
  .amdhsa_next_free_vgpr 168
  .amdhsa_next_free_sgpr 96
  .amdhsa_accum_offset 168
  .amdhsa_group_segment_fixed_size 0
  .amdhsa_kernarg_size 96
  .amdhsa_user_sgpr_count 2
  .amdhsa_user_sgpr_kernarg_segment_ptr 1
  .amdhsa_system_sgpr_workgroup_id_x 1
  .amdhsa_float_denorm_mode_32 3
.end_amdhsa_kernel
```
